```python
import torch

def _softmax(x, axis=-1):
    return torch.softmax(x, dim=axis)
def _gelu(x):
    return torch.nn.functional.gelu(x, approximate="tanh")
def _silu(x):
    return torch.nn.functional.silu(x)
def _sigmoid(x):
    return torch.sigmoid(x)
def _layernorm(x, axis=-1, eps=1e-5):
    m = x.mean(dim=axis, keepdim=True)
    v = x.var(dim=axis, keepdim=True, unbiased=False)
    return (x - m) / torch.sqrt(v + eps)
def _scatter_add(tgt, idx, src, axis=0):
    return tgt.clone().index_add_(axis, idx, src)
def _segment_sum(src, seg, n):
    out = torch.zeros((n,) + src.shape[1:], dtype=src.dtype)
    return out.index_add_(0, seg, src)
def _pad(x, pw):
    flat = tuple(v for pair in reversed(pw) for v in pair)
    return torch.nn.functional.pad(x, flat)

kernel_name = 'gated_mix__gqa_block_cached__compressed_kv_cla__decode'

def setup_inputs():

    _w = (lambda a: (lambda t: t.to(torch.bfloat16) if t.is_floating_point() else t)(torch.as_tensor(a)))
    def _A_setup():
        B, Sq, D = 2, 1, 576
        Hq, Hkv, Sk, Dh = 32, 16, 4096, 128
        assert Hq % Hkv == 0, (Hq, Hkv)
        return {
            "x": _w((lambda *s: torch.randn(*s, dtype=torch.bfloat16) * 0.05)(B, Sq, D)),
            "k_cache": _w((lambda *s: torch.randn(*s, dtype=torch.bfloat16) * 6.4)(B, Hkv, Sk, Dh)),
            "v_cache": _w((lambda *s: torch.randn(*s, dtype=torch.bfloat16) * 0.8)(B, Hkv, Sk, Dh)),
            "wq": _w((lambda *s: torch.randn(*s, dtype=torch.bfloat16) * 6.4)(D, Hq * Dh) * (D ** -0.5)),
            "wo": _w((lambda *s: torch.randn(*s, dtype=torch.bfloat16) * 0.8)(Hq * Dh, D) * ((Hq * Dh) ** -0.5)),
        }
    _A_in = _A_setup()

    def _B_setup():
        B, H, Sq, Sk, D, M = 2, 32, 1, 4096, 128, 576
        Dc = 4 * D
        return {
            "x": _w((lambda *s: torch.randn(*s, dtype=torch.bfloat16) * 0.05)(B, Sq, M)),
            "c_kv": _w((lambda *s: torch.randn(*s, dtype=torch.bfloat16) * 0.8)(B, Sk, Dc)),
            "w_q": _w((lambda *s: torch.randn(*s, dtype=torch.bfloat16) * 6.4)(M, H, D) * (M ** -0.5)),
            "w_uk": _w((lambda *s: torch.randn(*s, dtype=torch.bfloat16) * 6.4)(Dc, H, D) * (Dc ** -0.5)),
            "w_uv": _w((lambda *s: torch.randn(*s, dtype=torch.bfloat16) * 0.8)(Dc, H, D) * (Dc ** -0.5)),
            "w_o": _w((lambda *s: torch.randn(*s, dtype=torch.bfloat16) * 0.8)(H, D, M) * ((H * D) ** -0.5)),
        }
    _B_in = _B_setup()

    return {
        "A_x": _A_in["x"],
        "A_k_cache": _A_in["k_cache"],
        "A_v_cache": _A_in["v_cache"],
        "A_wq": _A_in["wq"],
        "A_wo": _A_in["wo"],
        "B_x": _B_in["x"],
        "B_c_kv": _B_in["c_kv"],
        "B_w_q": _B_in["w_q"],
        "B_w_uk": _B_in["w_uk"],
        "B_w_uv": _B_in["w_uv"],
        "B_w_o": _B_in["w_o"],
        "gate_w": _w((lambda *s: torch.randn(*s, dtype=torch.bfloat16) * 0.05)(576) * 16.0),
    }

def reference(A_x, A_k_cache, A_v_cache, A_wq, A_wo, B_x, B_c_kv, B_w_q, B_w_uk, B_w_uv, B_w_o, gate_w):
    def _A_ref(x, k_cache, v_cache, wq, wo):
        B, Sq, D = x.shape
        Hq, Dh = 32, 128
        Hkv = k_cache.shape[1]
        rep = Hq // Hkv
        q = (lambda x, *d: x.permute(*d))((x @ wq).reshape(B, Sq, Hq, Dh), 0, 2, 1, 3)
        k = (lambda x, n, axis: torch.repeat_interleave(x, n, dim=axis))(k_cache, rep, axis=1)
        v = (lambda x, n, axis: torch.repeat_interleave(x, n, dim=axis))(v_cache, rep, axis=1)
        scores = torch.einsum("bhqd,bhkd->bhqk", q, k) * (Dh ** -0.5)
        p = _softmax(scores, axis=-1)
        o = torch.einsum("bhqk,bhkd->bhqd", p, v)
        return (lambda x, *d: x.permute(*d))(o, 0, 2, 1, 3).reshape(B, Sq, Hq * Dh) @ wo

    def _B_ref(x, c_kv, w_q, w_uk, w_uv, w_o):
        B, Sq, M = x.shape[0], x.shape[1], x.shape[2]
        Sk = c_kv.shape[1]
        H, D = w_q.shape[1], w_q.shape[2]
        q = torch.einsum("bqm,mhd->bhqd", x, w_q)
        k = torch.einsum("bkc,chd->bhkd", c_kv, w_uk)
        v = torch.einsum("bkc,chd->bhkd", c_kv, w_uv)
        scores = torch.einsum("bhqd,bhkd->bhqk", q, k) * (D ** -0.5)
        off = Sk - Sq
        qi = torch.arange(Sq)[:, None]
        kj = torch.arange(Sk)[None, :]
        cmask = kj <= (qi + off)
        scores = torch.where(cmask[None, None], scores, -1e9)
        p = _softmax(scores, axis=-1)
        ctx = torch.einsum("bhqk,bhkd->bhqd", p, v)
        return torch.einsum("bhqd,hdm->bqm", ctx, w_o)

    x = A_x
    g = _sigmoid((x * gate_w).sum(-1, keepdims=True))
    a = _A_ref(x, A_k_cache, A_v_cache, A_wq, A_wo)
    b = _B_ref(x, B_c_kv, B_w_q, B_w_uk, B_w_uv, B_w_o)
    return g * a + (1 - g) * b
```

```asm
; @launch grid=(256,1,1) block=(1024,1,1) lds=153088
.amdgcn_target "amdgcn-amd-amdhsa--gfx950"
.text
.globl gated_mix__gqa_block_cached__compressed_kv_cla__decode_kernel
.p2align 8
.type gated_mix__gqa_block_cached__compressed_kv_cla__decode_kernel,@function
gated_mix__gqa_block_cached__compressed_kv_cla__decode_kernel:
  s_cmp_ge_u32 s2, 256
  s_cbranch_scc1 L_exit
  s_load_dwordx4 s[44:47], s[0:1], 104
  s_load_dwordx2 s[48:49], s[0:1], 0
  v_lshrrev_b32 v1, 6, v0
  v_and_b32 v2, 63, v0
  v_readfirstlane_b32 s3, v1
  v_lshrrev_b32 v3, 4, v2
  v_and_b32 v4, 15, v2
  s_mov_b32 s40, 0x3e0293ee
  s_mov_b32 s63, s3
  s_mov_b32 s62, 0
  s_cmp_ge_u32 s3, 8
  s_cbranch_scc1 L_C
  s_load_dwordx4 s[52:55], s[0:1], 8
  s_waitcnt lgkmcnt(0)
  s_mov_b32 s4, s46
  s_and_b32 s5, s47, 0xffff
  s_mov_b32 s6, 13631488
  s_mov_b32 s7, 0x20000
  s_mov_b32 s8, s44
  s_and_b32 s9, s45, 0xffff
  s_mov_b32 s10, 256
  s_mov_b32 s11, 0x20000
  s_mov_b32 s16, s52
  s_and_b32 s17, s53, 0xffff
  s_mov_b32 s18, 33554432
  s_mov_b32 s19, 0x20000
  s_mov_b32 s20, s54
  s_and_b32 s21, s55, 0xffff
  s_mov_b32 s22, 33554432
  s_mov_b32 s23, 0x20000
  s_lshl_b32 s32, s2, 17
  s_lshl_b32 s33, s3, 14
  s_add_u32 s32, s32, s33
  v_lshlrev_b32 v5, 8, v3
  v_lshl_add_u32 v5, v4, 4, v5
  v_add_u32 v5, s32, v5
  s_mov_b32 s44, 0
  s_mov_b32 s45, 4096
  s_mov_b32 s46, 8192
  s_mov_b32 s47, 12288
  s_cmp_lg_u32 s3, 0
  s_cbranch_scc1 L_A_noinit
  v_lshlrev_b32 v6, 2, v2
  v_mov_b32 v7, 0
  ds_write_b32 v6, v7
  s_waitcnt lgkmcnt(0)
L_A_noinit:
  s_barrier
  v_mov_b32 v6, 28
L_qlw_1:
  ds_read_b32 v7, v6
  s_waitcnt lgkmcnt(0)
  v_readfirstlane_b32 s32, v7
  s_nop 0
  s_cmp_ge_u32 s32, 8
  s_cbranch_scc1 L_qlw_1_d
  s_add_u32 s62, s62, 1
  s_cmp_gt_u32 s62, 0x1000000
  s_cbranch_scc1 L_bail
  s_sleep 1
  s_branch L_qlw_1
L_qlw_1_d:
  buffer_load_dwordx4 v[64:67], v5, s[16:19], s44 offen offset:0 nt
  buffer_load_dwordx4 v[68:71], v5, s[16:19], s44 offen offset:1024 nt
  buffer_load_dwordx4 v[72:75], v5, s[16:19], s44 offen offset:2048 nt
  s_waitcnt vmcnt(2)
  buffer_load_dwordx4 v[76:79], v5, s[16:19], s44 offen offset:3072 nt
  s_waitcnt vmcnt(2)
  buffer_load_dwordx4 v[80:83], v5, s[16:19], s45 offen offset:0 nt
  s_waitcnt vmcnt(2)
  buffer_load_dwordx4 v[84:87], v5, s[16:19], s45 offen offset:1024 nt
  s_waitcnt vmcnt(2)
  buffer_load_dwordx4 v[88:91], v5, s[16:19], s45 offen offset:2048 nt
  s_waitcnt vmcnt(2)
  buffer_load_dwordx4 v[92:95], v5, s[16:19], s45 offen offset:3072 nt
  s_waitcnt vmcnt(2)
  buffer_load_dwordx4 v[96:99], v5, s[16:19], s46 offen offset:0 nt
  s_waitcnt vmcnt(2)
  buffer_load_dwordx4 v[100:103], v5, s[16:19], s46 offen offset:1024 nt
  s_waitcnt vmcnt(2)
  buffer_load_dwordx4 v[104:107], v5, s[16:19], s46 offen offset:2048 nt
  s_waitcnt vmcnt(2)
  buffer_load_dwordx4 v[108:111], v5, s[16:19], s46 offen offset:3072 nt
  s_waitcnt vmcnt(2)
  buffer_load_dwordx4 v[112:115], v5, s[16:19], s47 offen offset:0 nt
  s_waitcnt vmcnt(2)
  buffer_load_dwordx4 v[116:119], v5, s[16:19], s47 offen offset:1024 nt
  s_waitcnt vmcnt(2)
  buffer_load_dwordx4 v[120:123], v5, s[16:19], s47 offen offset:2048 nt
  s_waitcnt vmcnt(2)
  buffer_load_dwordx4 v[124:127], v5, s[16:19], s47 offen offset:3072 nt
L_tag_2:
  v_mov_b32 v6, 192
  ds_read_b32 v6, v6
  s_waitcnt lgkmcnt(0)
  v_readfirstlane_b32 s39, v6
  s_add_u32 s62, s62, 1
  s_cmp_gt_u32 s62, 0x1000000
  s_cbranch_scc1 L_bail
  s_cmp_lg_u32 s39, 0
  s_cbranch_scc1 L_tag_2_d
  s_sleep 1
  s_branch L_tag_2
L_tag_2_d:
  v_mov_b32 v6, 128
L_lw_3:
  ds_read_b32 v7, v6
  s_waitcnt lgkmcnt(0)
  v_readfirstlane_b32 s32, v7
  s_nop 0
  s_cmp_lg_u32 s32, 0
  s_cbranch_scc1 L_lw_3_d
  s_add_u32 s62, s62, 1
  s_cmp_gt_u32 s62, 0x1000000
  s_cbranch_scc1 L_bail
  s_sleep 1
  s_branch L_lw_3
L_lw_3_d:
  v_lshlrev_b32 v10, 4, v4
  ds_read_b128 v[48:51], v10 offset:256
  ds_read_b128 v[52:55], v10 offset:512
  v_mov_b32 v16, 0
  v_mov_b32 v17, 0
  v_mov_b32 v18, 0
  v_mov_b32 v19, 0
  v_mov_b32 v20, 0
  v_mov_b32 v21, 0
  v_mov_b32 v22, 0
  v_mov_b32 v23, 0
  v_mov_b32 v24, 0
  v_mov_b32 v25, 0
  v_mov_b32 v26, 0
  v_mov_b32 v27, 0
  v_mov_b32 v28, 0
  v_mov_b32 v29, 0
  v_mov_b32 v30, 0
  v_mov_b32 v31, 0
  v_mov_b32 v32, 0
  v_mov_b32 v33, 0
  v_mov_b32 v34, 0
  v_mov_b32 v35, 0
  v_mov_b32 v36, 0
  v_mov_b32 v37, 0
  v_mov_b32 v38, 0
  v_mov_b32 v39, 0
  v_mov_b32 v40, 0
  v_mov_b32 v41, 0
  v_mov_b32 v42, 0
  v_mov_b32 v43, 0
  v_mov_b32 v44, 0
  v_mov_b32 v45, 0
  v_mov_b32 v46, 0
  v_mov_b32 v47, 0
  s_waitcnt vmcnt(0) lgkmcnt(0)
  v_dot2c_f32_bf16 v16, v64, v48
  v_dot2c_f32_bf16 v17, v64, v52
  v_dot2c_f32_bf16 v16, v65, v49
  v_dot2c_f32_bf16 v17, v65, v53
  v_dot2c_f32_bf16 v16, v66, v50
  v_dot2c_f32_bf16 v17, v66, v54
  v_dot2c_f32_bf16 v16, v67, v51
  v_dot2c_f32_bf16 v17, v67, v55
  v_dot2c_f32_bf16 v18, v68, v48
  v_dot2c_f32_bf16 v19, v68, v52
  v_dot2c_f32_bf16 v18, v69, v49
  v_dot2c_f32_bf16 v19, v69, v53
  v_dot2c_f32_bf16 v18, v70, v50
  v_dot2c_f32_bf16 v19, v70, v54
  v_dot2c_f32_bf16 v18, v71, v51
  v_dot2c_f32_bf16 v19, v71, v55
  v_dot2c_f32_bf16 v20, v72, v48
  v_dot2c_f32_bf16 v21, v72, v52
  v_dot2c_f32_bf16 v20, v73, v49
  v_dot2c_f32_bf16 v21, v73, v53
  v_dot2c_f32_bf16 v20, v74, v50
  v_dot2c_f32_bf16 v21, v74, v54
  v_dot2c_f32_bf16 v20, v75, v51
  v_dot2c_f32_bf16 v21, v75, v55
  v_dot2c_f32_bf16 v22, v76, v48
  v_dot2c_f32_bf16 v23, v76, v52
  v_dot2c_f32_bf16 v22, v77, v49
  v_dot2c_f32_bf16 v23, v77, v53
  v_dot2c_f32_bf16 v22, v78, v50
  v_dot2c_f32_bf16 v23, v78, v54
  v_dot2c_f32_bf16 v22, v79, v51
  v_dot2c_f32_bf16 v23, v79, v55
  v_dot2c_f32_bf16 v24, v80, v48
  v_dot2c_f32_bf16 v25, v80, v52
  v_dot2c_f32_bf16 v24, v81, v49
  v_dot2c_f32_bf16 v25, v81, v53
  v_dot2c_f32_bf16 v24, v82, v50
  v_dot2c_f32_bf16 v25, v82, v54
  v_dot2c_f32_bf16 v24, v83, v51
  v_dot2c_f32_bf16 v25, v83, v55
  v_dot2c_f32_bf16 v26, v84, v48
  v_dot2c_f32_bf16 v27, v84, v52
  v_dot2c_f32_bf16 v26, v85, v49
  v_dot2c_f32_bf16 v27, v85, v53
  v_dot2c_f32_bf16 v26, v86, v50
  v_dot2c_f32_bf16 v27, v86, v54
  v_dot2c_f32_bf16 v26, v87, v51
  v_dot2c_f32_bf16 v27, v87, v55
  v_dot2c_f32_bf16 v28, v88, v48
  v_dot2c_f32_bf16 v29, v88, v52
  v_dot2c_f32_bf16 v28, v89, v49
  v_dot2c_f32_bf16 v29, v89, v53
  v_dot2c_f32_bf16 v28, v90, v50
  v_dot2c_f32_bf16 v29, v90, v54
  v_dot2c_f32_bf16 v28, v91, v51
  v_dot2c_f32_bf16 v29, v91, v55
  v_dot2c_f32_bf16 v30, v92, v48
  v_dot2c_f32_bf16 v31, v92, v52
  v_dot2c_f32_bf16 v30, v93, v49
  v_dot2c_f32_bf16 v31, v93, v53
  v_dot2c_f32_bf16 v30, v94, v50
  v_dot2c_f32_bf16 v31, v94, v54
  v_dot2c_f32_bf16 v30, v95, v51
  v_dot2c_f32_bf16 v31, v95, v55
  v_dot2c_f32_bf16 v32, v96, v48
  v_dot2c_f32_bf16 v33, v96, v52
  v_dot2c_f32_bf16 v32, v97, v49
  v_dot2c_f32_bf16 v33, v97, v53
  v_dot2c_f32_bf16 v32, v98, v50
  v_dot2c_f32_bf16 v33, v98, v54
  v_dot2c_f32_bf16 v32, v99, v51
  v_dot2c_f32_bf16 v33, v99, v55
  v_dot2c_f32_bf16 v34, v100, v48
  v_dot2c_f32_bf16 v35, v100, v52
  v_dot2c_f32_bf16 v34, v101, v49
  v_dot2c_f32_bf16 v35, v101, v53
  v_dot2c_f32_bf16 v34, v102, v50
  v_dot2c_f32_bf16 v35, v102, v54
  v_dot2c_f32_bf16 v34, v103, v51
  v_dot2c_f32_bf16 v35, v103, v55
  v_dot2c_f32_bf16 v36, v104, v48
  v_dot2c_f32_bf16 v37, v104, v52
  v_dot2c_f32_bf16 v36, v105, v49
  v_dot2c_f32_bf16 v37, v105, v53
  v_dot2c_f32_bf16 v36, v106, v50
  v_dot2c_f32_bf16 v37, v106, v54
  v_dot2c_f32_bf16 v36, v107, v51
  v_dot2c_f32_bf16 v37, v107, v55
  v_dot2c_f32_bf16 v38, v108, v48
  v_dot2c_f32_bf16 v39, v108, v52
  v_dot2c_f32_bf16 v38, v109, v49
  v_dot2c_f32_bf16 v39, v109, v53
  v_dot2c_f32_bf16 v38, v110, v50
  v_dot2c_f32_bf16 v39, v110, v54
  v_dot2c_f32_bf16 v38, v111, v51
  v_dot2c_f32_bf16 v39, v111, v55
  v_dot2c_f32_bf16 v40, v112, v48
  v_dot2c_f32_bf16 v41, v112, v52
  v_dot2c_f32_bf16 v40, v113, v49
  v_dot2c_f32_bf16 v41, v113, v53
  v_dot2c_f32_bf16 v40, v114, v50
  v_dot2c_f32_bf16 v41, v114, v54
  v_dot2c_f32_bf16 v40, v115, v51
  v_dot2c_f32_bf16 v41, v115, v55
  v_dot2c_f32_bf16 v42, v116, v48
  v_dot2c_f32_bf16 v43, v116, v52
  v_dot2c_f32_bf16 v42, v117, v49
  v_dot2c_f32_bf16 v43, v117, v53
  v_dot2c_f32_bf16 v42, v118, v50
  v_dot2c_f32_bf16 v43, v118, v54
  v_dot2c_f32_bf16 v42, v119, v51
  v_dot2c_f32_bf16 v43, v119, v55
  v_dot2c_f32_bf16 v44, v120, v48
  v_dot2c_f32_bf16 v45, v120, v52
  v_dot2c_f32_bf16 v44, v121, v49
  v_dot2c_f32_bf16 v45, v121, v53
  v_dot2c_f32_bf16 v44, v122, v50
  v_dot2c_f32_bf16 v45, v122, v54
  v_dot2c_f32_bf16 v44, v123, v51
  v_dot2c_f32_bf16 v45, v123, v55
  v_dot2c_f32_bf16 v46, v124, v48
  v_dot2c_f32_bf16 v47, v124, v52
  v_dot2c_f32_bf16 v46, v125, v49
  v_dot2c_f32_bf16 v47, v125, v53
  v_dot2c_f32_bf16 v46, v126, v50
  v_dot2c_f32_bf16 v47, v126, v54
  v_dot2c_f32_bf16 v46, v127, v51
  v_dot2c_f32_bf16 v47, v127, v55
  buffer_load_dwordx4 v[64:67], v5, s[20:23], s44 offen offset:0 nt
  buffer_load_dwordx4 v[68:71], v5, s[20:23], s44 offen offset:1024 nt
  buffer_load_dwordx4 v[72:75], v5, s[20:23], s44 offen offset:2048 nt
  s_nop 3
  v_add_f32_dpp v16, v16, v16 row_ror:8 row_mask:0xf bank_mask:0xf
  v_add_f32_dpp v17, v17, v17 row_ror:8 row_mask:0xf bank_mask:0xf
  v_add_f32_dpp v18, v18, v18 row_ror:8 row_mask:0xf bank_mask:0xf
  v_add_f32_dpp v19, v19, v19 row_ror:8 row_mask:0xf bank_mask:0xf
  v_add_f32_dpp v20, v20, v20 row_ror:8 row_mask:0xf bank_mask:0xf
  v_add_f32_dpp v21, v21, v21 row_ror:8 row_mask:0xf bank_mask:0xf
  v_add_f32_dpp v22, v22, v22 row_ror:8 row_mask:0xf bank_mask:0xf
  v_add_f32_dpp v23, v23, v23 row_ror:8 row_mask:0xf bank_mask:0xf
  v_add_f32_dpp v24, v24, v24 row_ror:8 row_mask:0xf bank_mask:0xf
  v_add_f32_dpp v25, v25, v25 row_ror:8 row_mask:0xf bank_mask:0xf
  v_add_f32_dpp v26, v26, v26 row_ror:8 row_mask:0xf bank_mask:0xf
  v_add_f32_dpp v27, v27, v27 row_ror:8 row_mask:0xf bank_mask:0xf
  v_add_f32_dpp v28, v28, v28 row_ror:8 row_mask:0xf bank_mask:0xf
  v_add_f32_dpp v29, v29, v29 row_ror:8 row_mask:0xf bank_mask:0xf
  v_add_f32_dpp v30, v30, v30 row_ror:8 row_mask:0xf bank_mask:0xf
  v_add_f32_dpp v31, v31, v31 row_ror:8 row_mask:0xf bank_mask:0xf
  v_add_f32_dpp v32, v32, v32 row_ror:8 row_mask:0xf bank_mask:0xf
  v_add_f32_dpp v33, v33, v33 row_ror:8 row_mask:0xf bank_mask:0xf
  v_add_f32_dpp v34, v34, v34 row_ror:8 row_mask:0xf bank_mask:0xf
  v_add_f32_dpp v35, v35, v35 row_ror:8 row_mask:0xf bank_mask:0xf
  v_add_f32_dpp v36, v36, v36 row_ror:8 row_mask:0xf bank_mask:0xf
  v_add_f32_dpp v37, v37, v37 row_ror:8 row_mask:0xf bank_mask:0xf
  v_add_f32_dpp v38, v38, v38 row_ror:8 row_mask:0xf bank_mask:0xf
  v_add_f32_dpp v39, v39, v39 row_ror:8 row_mask:0xf bank_mask:0xf
  v_add_f32_dpp v40, v40, v40 row_ror:8 row_mask:0xf bank_mask:0xf
  v_add_f32_dpp v41, v41, v41 row_ror:8 row_mask:0xf bank_mask:0xf
  v_add_f32_dpp v42, v42, v42 row_ror:8 row_mask:0xf bank_mask:0xf
  v_add_f32_dpp v43, v43, v43 row_ror:8 row_mask:0xf bank_mask:0xf
  v_add_f32_dpp v44, v44, v44 row_ror:8 row_mask:0xf bank_mask:0xf
  v_add_f32_dpp v45, v45, v45 row_ror:8 row_mask:0xf bank_mask:0xf
  v_add_f32_dpp v46, v46, v46 row_ror:8 row_mask:0xf bank_mask:0xf
  v_add_f32_dpp v47, v47, v47 row_ror:8 row_mask:0xf bank_mask:0xf
  v_add_f32_dpp v16, v16, v16 row_ror:4 row_mask:0xf bank_mask:0xf
  v_add_f32_dpp v17, v17, v17 row_ror:4 row_mask:0xf bank_mask:0xf
  v_add_f32_dpp v18, v18, v18 row_ror:4 row_mask:0xf bank_mask:0xf
  v_add_f32_dpp v19, v19, v19 row_ror:4 row_mask:0xf bank_mask:0xf
  v_add_f32_dpp v20, v20, v20 row_ror:4 row_mask:0xf bank_mask:0xf
  v_add_f32_dpp v21, v21, v21 row_ror:4 row_mask:0xf bank_mask:0xf
  v_add_f32_dpp v22, v22, v22 row_ror:4 row_mask:0xf bank_mask:0xf
  v_add_f32_dpp v23, v23, v23 row_ror:4 row_mask:0xf bank_mask:0xf
  v_add_f32_dpp v24, v24, v24 row_ror:4 row_mask:0xf bank_mask:0xf
  v_add_f32_dpp v25, v25, v25 row_ror:4 row_mask:0xf bank_mask:0xf
  v_add_f32_dpp v26, v26, v26 row_ror:4 row_mask:0xf bank_mask:0xf
  v_add_f32_dpp v27, v27, v27 row_ror:4 row_mask:0xf bank_mask:0xf
  v_add_f32_dpp v28, v28, v28 row_ror:4 row_mask:0xf bank_mask:0xf
  v_add_f32_dpp v29, v29, v29 row_ror:4 row_mask:0xf bank_mask:0xf
  v_add_f32_dpp v30, v30, v30 row_ror:4 row_mask:0xf bank_mask:0xf
  v_add_f32_dpp v31, v31, v31 row_ror:4 row_mask:0xf bank_mask:0xf
  v_add_f32_dpp v32, v32, v32 row_ror:4 row_mask:0xf bank_mask:0xf
  v_add_f32_dpp v33, v33, v33 row_ror:4 row_mask:0xf bank_mask:0xf
  v_add_f32_dpp v34, v34, v34 row_ror:4 row_mask:0xf bank_mask:0xf
  v_add_f32_dpp v35, v35, v35 row_ror:4 row_mask:0xf bank_mask:0xf
  v_add_f32_dpp v36, v36, v36 row_ror:4 row_mask:0xf bank_mask:0xf
  v_add_f32_dpp v37, v37, v37 row_ror:4 row_mask:0xf bank_mask:0xf
  v_add_f32_dpp v38, v38, v38 row_ror:4 row_mask:0xf bank_mask:0xf
  v_add_f32_dpp v39, v39, v39 row_ror:4 row_mask:0xf bank_mask:0xf
  v_add_f32_dpp v40, v40, v40 row_ror:4 row_mask:0xf bank_mask:0xf
  v_add_f32_dpp v41, v41, v41 row_ror:4 row_mask:0xf bank_mask:0xf
  v_add_f32_dpp v42, v42, v42 row_ror:4 row_mask:0xf bank_mask:0xf
  v_add_f32_dpp v43, v43, v43 row_ror:4 row_mask:0xf bank_mask:0xf
  v_add_f32_dpp v44, v44, v44 row_ror:4 row_mask:0xf bank_mask:0xf
  v_add_f32_dpp v45, v45, v45 row_ror:4 row_mask:0xf bank_mask:0xf
  v_add_f32_dpp v46, v46, v46 row_ror:4 row_mask:0xf bank_mask:0xf
  v_add_f32_dpp v47, v47, v47 row_ror:4 row_mask:0xf bank_mask:0xf
  v_add_f32_dpp v16, v16, v16 row_ror:2 row_mask:0xf bank_mask:0xf
  v_add_f32_dpp v17, v17, v17 row_ror:2 row_mask:0xf bank_mask:0xf
  v_add_f32_dpp v18, v18, v18 row_ror:2 row_mask:0xf bank_mask:0xf
  v_add_f32_dpp v19, v19, v19 row_ror:2 row_mask:0xf bank_mask:0xf
  v_add_f32_dpp v20, v20, v20 row_ror:2 row_mask:0xf bank_mask:0xf
  v_add_f32_dpp v21, v21, v21 row_ror:2 row_mask:0xf bank_mask:0xf
  v_add_f32_dpp v22, v22, v22 row_ror:2 row_mask:0xf bank_mask:0xf
  v_add_f32_dpp v23, v23, v23 row_ror:2 row_mask:0xf bank_mask:0xf
  v_add_f32_dpp v24, v24, v24 row_ror:2 row_mask:0xf bank_mask:0xf
  v_add_f32_dpp v25, v25, v25 row_ror:2 row_mask:0xf bank_mask:0xf
  v_add_f32_dpp v26, v26, v26 row_ror:2 row_mask:0xf bank_mask:0xf
  v_add_f32_dpp v27, v27, v27 row_ror:2 row_mask:0xf bank_mask:0xf
  v_add_f32_dpp v28, v28, v28 row_ror:2 row_mask:0xf bank_mask:0xf
  v_add_f32_dpp v29, v29, v29 row_ror:2 row_mask:0xf bank_mask:0xf
  v_add_f32_dpp v30, v30, v30 row_ror:2 row_mask:0xf bank_mask:0xf
  v_add_f32_dpp v31, v31, v31 row_ror:2 row_mask:0xf bank_mask:0xf
  v_add_f32_dpp v32, v32, v32 row_ror:2 row_mask:0xf bank_mask:0xf
  v_add_f32_dpp v33, v33, v33 row_ror:2 row_mask:0xf bank_mask:0xf
  v_add_f32_dpp v34, v34, v34 row_ror:2 row_mask:0xf bank_mask:0xf
  v_add_f32_dpp v35, v35, v35 row_ror:2 row_mask:0xf bank_mask:0xf
  v_add_f32_dpp v36, v36, v36 row_ror:2 row_mask:0xf bank_mask:0xf
  v_add_f32_dpp v37, v37, v37 row_ror:2 row_mask:0xf bank_mask:0xf
  v_add_f32_dpp v38, v38, v38 row_ror:2 row_mask:0xf bank_mask:0xf
  v_add_f32_dpp v39, v39, v39 row_ror:2 row_mask:0xf bank_mask:0xf
  v_add_f32_dpp v40, v40, v40 row_ror:2 row_mask:0xf bank_mask:0xf
  v_add_f32_dpp v41, v41, v41 row_ror:2 row_mask:0xf bank_mask:0xf
  v_add_f32_dpp v42, v42, v42 row_ror:2 row_mask:0xf bank_mask:0xf
  v_add_f32_dpp v43, v43, v43 row_ror:2 row_mask:0xf bank_mask:0xf
  v_add_f32_dpp v44, v44, v44 row_ror:2 row_mask:0xf bank_mask:0xf
  v_add_f32_dpp v45, v45, v45 row_ror:2 row_mask:0xf bank_mask:0xf
  v_add_f32_dpp v46, v46, v46 row_ror:2 row_mask:0xf bank_mask:0xf
  v_add_f32_dpp v47, v47, v47 row_ror:2 row_mask:0xf bank_mask:0xf
  v_add_f32_dpp v16, v16, v16 row_ror:1 row_mask:0xf bank_mask:0xf
  v_add_f32_dpp v17, v17, v17 row_ror:1 row_mask:0xf bank_mask:0xf
  v_add_f32_dpp v18, v18, v18 row_ror:1 row_mask:0xf bank_mask:0xf
  v_add_f32_dpp v19, v19, v19 row_ror:1 row_mask:0xf bank_mask:0xf
  v_add_f32_dpp v20, v20, v20 row_ror:1 row_mask:0xf bank_mask:0xf
  v_add_f32_dpp v21, v21, v21 row_ror:1 row_mask:0xf bank_mask:0xf
  v_add_f32_dpp v22, v22, v22 row_ror:1 row_mask:0xf bank_mask:0xf
  v_add_f32_dpp v23, v23, v23 row_ror:1 row_mask:0xf bank_mask:0xf
  v_add_f32_dpp v24, v24, v24 row_ror:1 row_mask:0xf bank_mask:0xf
  v_add_f32_dpp v25, v25, v25 row_ror:1 row_mask:0xf bank_mask:0xf
  v_add_f32_dpp v26, v26, v26 row_ror:1 row_mask:0xf bank_mask:0xf
  v_add_f32_dpp v27, v27, v27 row_ror:1 row_mask:0xf bank_mask:0xf
  v_add_f32_dpp v28, v28, v28 row_ror:1 row_mask:0xf bank_mask:0xf
  v_add_f32_dpp v29, v29, v29 row_ror:1 row_mask:0xf bank_mask:0xf
  v_add_f32_dpp v30, v30, v30 row_ror:1 row_mask:0xf bank_mask:0xf
  v_add_f32_dpp v31, v31, v31 row_ror:1 row_mask:0xf bank_mask:0xf
  v_add_f32_dpp v32, v32, v32 row_ror:1 row_mask:0xf bank_mask:0xf
  v_add_f32_dpp v33, v33, v33 row_ror:1 row_mask:0xf bank_mask:0xf
  v_add_f32_dpp v34, v34, v34 row_ror:1 row_mask:0xf bank_mask:0xf
  v_add_f32_dpp v35, v35, v35 row_ror:1 row_mask:0xf bank_mask:0xf
  v_add_f32_dpp v36, v36, v36 row_ror:1 row_mask:0xf bank_mask:0xf
  v_add_f32_dpp v37, v37, v37 row_ror:1 row_mask:0xf bank_mask:0xf
  v_add_f32_dpp v38, v38, v38 row_ror:1 row_mask:0xf bank_mask:0xf
  v_add_f32_dpp v39, v39, v39 row_ror:1 row_mask:0xf bank_mask:0xf
  v_add_f32_dpp v40, v40, v40 row_ror:1 row_mask:0xf bank_mask:0xf
  v_add_f32_dpp v41, v41, v41 row_ror:1 row_mask:0xf bank_mask:0xf
  v_add_f32_dpp v42, v42, v42 row_ror:1 row_mask:0xf bank_mask:0xf
  v_add_f32_dpp v43, v43, v43 row_ror:1 row_mask:0xf bank_mask:0xf
  v_add_f32_dpp v44, v44, v44 row_ror:1 row_mask:0xf bank_mask:0xf
  v_add_f32_dpp v45, v45, v45 row_ror:1 row_mask:0xf bank_mask:0xf
  v_add_f32_dpp v46, v46, v46 row_ror:1 row_mask:0xf bank_mask:0xf
  v_add_f32_dpp v47, v47, v47 row_ror:1 row_mask:0xf bank_mask:0xf
  v_max_f32 v56, v16, v18
  v_max_f32 v56, v56, v20
  v_max_f32 v56, v56, v22
  v_max_f32 v56, v56, v24
  v_max_f32 v56, v56, v26
  v_max_f32 v56, v56, v28
  v_max_f32 v56, v56, v30
  v_max_f32 v56, v56, v32
  v_max_f32 v56, v56, v34
  v_max_f32 v56, v56, v36
  v_max_f32 v56, v56, v38
  v_max_f32 v56, v56, v40
  v_max_f32 v56, v56, v42
  v_max_f32 v56, v56, v44
  v_max_f32 v56, v56, v46
  v_max_f32 v57, v17, v19
  v_max_f32 v57, v57, v21
  v_max_f32 v57, v57, v23
  v_max_f32 v57, v57, v25
  v_max_f32 v57, v57, v27
  v_max_f32 v57, v57, v29
  v_max_f32 v57, v57, v31
  v_max_f32 v57, v57, v33
  v_max_f32 v57, v57, v35
  v_max_f32 v57, v57, v37
  v_max_f32 v57, v57, v39
  v_max_f32 v57, v57, v41
  v_max_f32 v57, v57, v43
  v_max_f32 v57, v57, v45
  v_max_f32 v57, v57, v47
  v_mov_b32 v58, v56
  v_mov_b32 v59, v57
  s_nop 1
  v_permlane16_swap_b32 v56, v58
  v_permlane16_swap_b32 v57, v59
  s_nop 1
  v_max_f32 v56, v56, v58
  v_max_f32 v57, v57, v59
  v_mov_b32 v58, v56
  v_mov_b32 v59, v57
  s_nop 1
  v_permlane32_swap_b32 v56, v58
  v_permlane32_swap_b32 v57, v59
  s_nop 1
  v_max_f32 v56, v56, v58
  v_max_f32 v57, v57, v59
  v_mul_f32 v56, s40, v56
  v_mul_f32 v57, s40, v57
  v_fma_f32 v16, v16, s40, -v56
  v_fma_f32 v17, v17, s40, -v57
  v_fma_f32 v18, v18, s40, -v56
  v_fma_f32 v19, v19, s40, -v57
  v_fma_f32 v20, v20, s40, -v56
  v_fma_f32 v21, v21, s40, -v57
  v_fma_f32 v22, v22, s40, -v56
  v_fma_f32 v23, v23, s40, -v57
  v_fma_f32 v24, v24, s40, -v56
  v_fma_f32 v25, v25, s40, -v57
  v_fma_f32 v26, v26, s40, -v56
  v_fma_f32 v27, v27, s40, -v57
  v_fma_f32 v28, v28, s40, -v56
  v_fma_f32 v29, v29, s40, -v57
  v_fma_f32 v30, v30, s40, -v56
  v_fma_f32 v31, v31, s40, -v57
  v_fma_f32 v32, v32, s40, -v56
  v_fma_f32 v33, v33, s40, -v57
  v_fma_f32 v34, v34, s40, -v56
  v_fma_f32 v35, v35, s40, -v57
  v_fma_f32 v36, v36, s40, -v56
  v_fma_f32 v37, v37, s40, -v57
  v_fma_f32 v38, v38, s40, -v56
  v_fma_f32 v39, v39, s40, -v57
  v_fma_f32 v40, v40, s40, -v56
  v_fma_f32 v41, v41, s40, -v57
  v_fma_f32 v42, v42, s40, -v56
  v_fma_f32 v43, v43, s40, -v57
  v_fma_f32 v44, v44, s40, -v56
  v_fma_f32 v45, v45, s40, -v57
  v_fma_f32 v46, v46, s40, -v56
  v_fma_f32 v47, v47, s40, -v57
  v_exp_f32 v16, v16
  v_exp_f32 v17, v17
  v_exp_f32 v18, v18
  v_exp_f32 v19, v19
  v_exp_f32 v20, v20
  v_exp_f32 v21, v21
  v_exp_f32 v22, v22
  v_exp_f32 v23, v23
  v_exp_f32 v24, v24
  v_exp_f32 v25, v25
  v_exp_f32 v26, v26
  v_exp_f32 v27, v27
  v_exp_f32 v28, v28
  v_exp_f32 v29, v29
  v_exp_f32 v30, v30
  v_exp_f32 v31, v31
  v_exp_f32 v32, v32
  v_exp_f32 v33, v33
  v_exp_f32 v34, v34
  v_exp_f32 v35, v35
  v_exp_f32 v36, v36
  v_exp_f32 v37, v37
  v_exp_f32 v38, v38
  v_exp_f32 v39, v39
  v_exp_f32 v40, v40
  v_exp_f32 v41, v41
  v_exp_f32 v42, v42
  v_exp_f32 v43, v43
  v_exp_f32 v44, v44
  v_exp_f32 v45, v45
  v_exp_f32 v46, v46
  v_exp_f32 v47, v47
  s_nop 0
  v_add_f32 v58, v16, v18
  v_add_f32 v58, v58, v20
  v_add_f32 v58, v58, v22
  v_add_f32 v58, v58, v24
  v_add_f32 v58, v58, v26
  v_add_f32 v58, v58, v28
  v_add_f32 v58, v58, v30
  v_add_f32 v58, v58, v32
  v_add_f32 v58, v58, v34
  v_add_f32 v58, v58, v36
  v_add_f32 v58, v58, v38
  v_add_f32 v58, v58, v40
  v_add_f32 v58, v58, v42
  v_add_f32 v58, v58, v44
  v_add_f32 v58, v58, v46
  v_add_f32 v59, v17, v19
  v_add_f32 v59, v59, v21
  v_add_f32 v59, v59, v23
  v_add_f32 v59, v59, v25
  v_add_f32 v59, v59, v27
  v_add_f32 v59, v59, v29
  v_add_f32 v59, v59, v31
  v_add_f32 v59, v59, v33
  v_add_f32 v59, v59, v35
  v_add_f32 v59, v59, v37
  v_add_f32 v59, v59, v39
  v_add_f32 v59, v59, v41
  v_add_f32 v59, v59, v43
  v_add_f32 v59, v59, v45
  v_add_f32 v59, v59, v47
  v_mov_b32 v60, v58
  v_mov_b32 v61, v59
  s_nop 1
  v_permlane16_swap_b32 v58, v60
  v_permlane16_swap_b32 v59, v61
  s_nop 1
  v_add_f32 v58, v58, v60
  v_add_f32 v59, v59, v61
  v_mov_b32 v60, v58
  v_mov_b32 v61, v59
  s_nop 1
  v_permlane32_swap_b32 v58, v60
  v_permlane32_swap_b32 v59, v61
  s_nop 1
  v_add_f32 v58, v58, v60
  v_add_f32 v59, v59, v61
  v_mov_b32 v10, v56
  v_mov_b32 v11, v58
  v_mov_b32 v12, v57
  v_mov_b32 v13, v59
  v_mov_b32 v48, 0
  v_mov_b32 v49, 0
  v_mov_b32 v50, 0
  v_mov_b32 v51, 0
  v_mov_b32 v52, 0
  v_mov_b32 v53, 0
  v_mov_b32 v54, 0
  v_mov_b32 v55, 0
  v_mov_b32 v56, 0
  v_mov_b32 v57, 0
  v_mov_b32 v58, 0
  v_mov_b32 v59, 0
  v_mov_b32 v60, 0
  v_mov_b32 v61, 0
  v_mov_b32 v62, 0
  v_mov_b32 v63, 0
  s_waitcnt vmcnt(2)
  v_lshlrev_b32 v14, 16, v64
  v_and_b32 v15, 0xffff0000, v64
  v_fmac_f32 v48, v16, v14
  v_fmac_f32 v49, v16, v15
  v_fmac_f32 v56, v17, v14
  v_fmac_f32 v57, v17, v15
  v_lshlrev_b32 v14, 16, v65
  v_and_b32 v15, 0xffff0000, v65
  v_fmac_f32 v50, v16, v14
  v_fmac_f32 v51, v16, v15
  v_fmac_f32 v58, v17, v14
  v_fmac_f32 v59, v17, v15
  v_lshlrev_b32 v14, 16, v66
  v_and_b32 v15, 0xffff0000, v66
  v_fmac_f32 v52, v16, v14
  v_fmac_f32 v53, v16, v15
  v_fmac_f32 v60, v17, v14
  v_fmac_f32 v61, v17, v15
  v_lshlrev_b32 v14, 16, v67
  v_and_b32 v15, 0xffff0000, v67
  v_fmac_f32 v54, v16, v14
  v_fmac_f32 v55, v16, v15
  v_fmac_f32 v62, v17, v14
  v_fmac_f32 v63, v17, v15
  buffer_load_dwordx4 v[76:79], v5, s[20:23], s44 offen offset:3072 nt
  s_waitcnt vmcnt(2)
  v_lshlrev_b32 v14, 16, v68
  v_and_b32 v15, 0xffff0000, v68
  v_fmac_f32 v48, v18, v14
  v_fmac_f32 v49, v18, v15
  v_fmac_f32 v56, v19, v14
  v_fmac_f32 v57, v19, v15
  v_lshlrev_b32 v14, 16, v69
  v_and_b32 v15, 0xffff0000, v69
  v_fmac_f32 v50, v18, v14
  v_fmac_f32 v51, v18, v15
  v_fmac_f32 v58, v19, v14
  v_fmac_f32 v59, v19, v15
  v_lshlrev_b32 v14, 16, v70
  v_and_b32 v15, 0xffff0000, v70
  v_fmac_f32 v52, v18, v14
  v_fmac_f32 v53, v18, v15
  v_fmac_f32 v60, v19, v14
  v_fmac_f32 v61, v19, v15
  v_lshlrev_b32 v14, 16, v71
  v_and_b32 v15, 0xffff0000, v71
  v_fmac_f32 v54, v18, v14
  v_fmac_f32 v55, v18, v15
  v_fmac_f32 v62, v19, v14
  v_fmac_f32 v63, v19, v15
  buffer_load_dwordx4 v[80:83], v5, s[20:23], s45 offen offset:0 nt
  s_waitcnt vmcnt(2)
  v_lshlrev_b32 v14, 16, v72
  v_and_b32 v15, 0xffff0000, v72
  v_fmac_f32 v48, v20, v14
  v_fmac_f32 v49, v20, v15
  v_fmac_f32 v56, v21, v14
  v_fmac_f32 v57, v21, v15
  v_lshlrev_b32 v14, 16, v73
  v_and_b32 v15, 0xffff0000, v73
  v_fmac_f32 v50, v20, v14
  v_fmac_f32 v51, v20, v15
  v_fmac_f32 v58, v21, v14
  v_fmac_f32 v59, v21, v15
  v_lshlrev_b32 v14, 16, v74
  v_and_b32 v15, 0xffff0000, v74
  v_fmac_f32 v52, v20, v14
  v_fmac_f32 v53, v20, v15
  v_fmac_f32 v60, v21, v14
  v_fmac_f32 v61, v21, v15
  v_lshlrev_b32 v14, 16, v75
  v_and_b32 v15, 0xffff0000, v75
  v_fmac_f32 v54, v20, v14
  v_fmac_f32 v55, v20, v15
  v_fmac_f32 v62, v21, v14
  v_fmac_f32 v63, v21, v15
  buffer_load_dwordx4 v[84:87], v5, s[20:23], s45 offen offset:1024 nt
  s_waitcnt vmcnt(2)
  v_lshlrev_b32 v14, 16, v76
  v_and_b32 v15, 0xffff0000, v76
  v_fmac_f32 v48, v22, v14
  v_fmac_f32 v49, v22, v15
  v_fmac_f32 v56, v23, v14
  v_fmac_f32 v57, v23, v15
  v_lshlrev_b32 v14, 16, v77
  v_and_b32 v15, 0xffff0000, v77
  v_fmac_f32 v50, v22, v14
  v_fmac_f32 v51, v22, v15
  v_fmac_f32 v58, v23, v14
  v_fmac_f32 v59, v23, v15
  v_lshlrev_b32 v14, 16, v78
  v_and_b32 v15, 0xffff0000, v78
  v_fmac_f32 v52, v22, v14
  v_fmac_f32 v53, v22, v15
  v_fmac_f32 v60, v23, v14
  v_fmac_f32 v61, v23, v15
  v_lshlrev_b32 v14, 16, v79
  v_and_b32 v15, 0xffff0000, v79
  v_fmac_f32 v54, v22, v14
  v_fmac_f32 v55, v22, v15
  v_fmac_f32 v62, v23, v14
  v_fmac_f32 v63, v23, v15
  buffer_load_dwordx4 v[88:91], v5, s[20:23], s45 offen offset:2048 nt
  s_waitcnt vmcnt(2)
  v_lshlrev_b32 v14, 16, v80
  v_and_b32 v15, 0xffff0000, v80
  v_fmac_f32 v48, v24, v14
  v_fmac_f32 v49, v24, v15
  v_fmac_f32 v56, v25, v14
  v_fmac_f32 v57, v25, v15
  v_lshlrev_b32 v14, 16, v81
  v_and_b32 v15, 0xffff0000, v81
  v_fmac_f32 v50, v24, v14
  v_fmac_f32 v51, v24, v15
  v_fmac_f32 v58, v25, v14
  v_fmac_f32 v59, v25, v15
  v_lshlrev_b32 v14, 16, v82
  v_and_b32 v15, 0xffff0000, v82
  v_fmac_f32 v52, v24, v14
  v_fmac_f32 v53, v24, v15
  v_fmac_f32 v60, v25, v14
  v_fmac_f32 v61, v25, v15
  v_lshlrev_b32 v14, 16, v83
  v_and_b32 v15, 0xffff0000, v83
  v_fmac_f32 v54, v24, v14
  v_fmac_f32 v55, v24, v15
  v_fmac_f32 v62, v25, v14
  v_fmac_f32 v63, v25, v15
  buffer_load_dwordx4 v[92:95], v5, s[20:23], s45 offen offset:3072 nt
  s_waitcnt vmcnt(2)
  v_lshlrev_b32 v14, 16, v84
  v_and_b32 v15, 0xffff0000, v84
  v_fmac_f32 v48, v26, v14
  v_fmac_f32 v49, v26, v15
  v_fmac_f32 v56, v27, v14
  v_fmac_f32 v57, v27, v15
  v_lshlrev_b32 v14, 16, v85
  v_and_b32 v15, 0xffff0000, v85
  v_fmac_f32 v50, v26, v14
  v_fmac_f32 v51, v26, v15
  v_fmac_f32 v58, v27, v14
  v_fmac_f32 v59, v27, v15
  v_lshlrev_b32 v14, 16, v86
  v_and_b32 v15, 0xffff0000, v86
  v_fmac_f32 v52, v26, v14
  v_fmac_f32 v53, v26, v15
  v_fmac_f32 v60, v27, v14
  v_fmac_f32 v61, v27, v15
  v_lshlrev_b32 v14, 16, v87
  v_and_b32 v15, 0xffff0000, v87
  v_fmac_f32 v54, v26, v14
  v_fmac_f32 v55, v26, v15
  v_fmac_f32 v62, v27, v14
  v_fmac_f32 v63, v27, v15
  buffer_load_dwordx4 v[96:99], v5, s[20:23], s46 offen offset:0 nt
  s_waitcnt vmcnt(2)
  v_lshlrev_b32 v14, 16, v88
  v_and_b32 v15, 0xffff0000, v88
  v_fmac_f32 v48, v28, v14
  v_fmac_f32 v49, v28, v15
  v_fmac_f32 v56, v29, v14
  v_fmac_f32 v57, v29, v15
  v_lshlrev_b32 v14, 16, v89
  v_and_b32 v15, 0xffff0000, v89
  v_fmac_f32 v50, v28, v14
  v_fmac_f32 v51, v28, v15
  v_fmac_f32 v58, v29, v14
  v_fmac_f32 v59, v29, v15
  v_lshlrev_b32 v14, 16, v90
  v_and_b32 v15, 0xffff0000, v90
  v_fmac_f32 v52, v28, v14
  v_fmac_f32 v53, v28, v15
  v_fmac_f32 v60, v29, v14
  v_fmac_f32 v61, v29, v15
  v_lshlrev_b32 v14, 16, v91
  v_and_b32 v15, 0xffff0000, v91
  v_fmac_f32 v54, v28, v14
  v_fmac_f32 v55, v28, v15
  v_fmac_f32 v62, v29, v14
  v_fmac_f32 v63, v29, v15
  buffer_load_dwordx4 v[100:103], v5, s[20:23], s46 offen offset:1024 nt
  s_waitcnt vmcnt(2)
  v_lshlrev_b32 v14, 16, v92
  v_and_b32 v15, 0xffff0000, v92
  v_fmac_f32 v48, v30, v14
  v_fmac_f32 v49, v30, v15
  v_fmac_f32 v56, v31, v14
  v_fmac_f32 v57, v31, v15
  v_lshlrev_b32 v14, 16, v93
  v_and_b32 v15, 0xffff0000, v93
  v_fmac_f32 v50, v30, v14
  v_fmac_f32 v51, v30, v15
  v_fmac_f32 v58, v31, v14
  v_fmac_f32 v59, v31, v15
  v_lshlrev_b32 v14, 16, v94
  v_and_b32 v15, 0xffff0000, v94
  v_fmac_f32 v52, v30, v14
  v_fmac_f32 v53, v30, v15
  v_fmac_f32 v60, v31, v14
  v_fmac_f32 v61, v31, v15
  v_lshlrev_b32 v14, 16, v95
  v_and_b32 v15, 0xffff0000, v95
  v_fmac_f32 v54, v30, v14
  v_fmac_f32 v55, v30, v15
  v_fmac_f32 v62, v31, v14
  v_fmac_f32 v63, v31, v15
  buffer_load_dwordx4 v[104:107], v5, s[20:23], s46 offen offset:2048 nt
  s_waitcnt vmcnt(2)
  v_lshlrev_b32 v14, 16, v96
  v_and_b32 v15, 0xffff0000, v96
  v_fmac_f32 v48, v32, v14
  v_fmac_f32 v49, v32, v15
  v_fmac_f32 v56, v33, v14
  v_fmac_f32 v57, v33, v15
  v_lshlrev_b32 v14, 16, v97
  v_and_b32 v15, 0xffff0000, v97
  v_fmac_f32 v50, v32, v14
  v_fmac_f32 v51, v32, v15
  v_fmac_f32 v58, v33, v14
  v_fmac_f32 v59, v33, v15
  v_lshlrev_b32 v14, 16, v98
  v_and_b32 v15, 0xffff0000, v98
  v_fmac_f32 v52, v32, v14
  v_fmac_f32 v53, v32, v15
  v_fmac_f32 v60, v33, v14
  v_fmac_f32 v61, v33, v15
  v_lshlrev_b32 v14, 16, v99
  v_and_b32 v15, 0xffff0000, v99
  v_fmac_f32 v54, v32, v14
  v_fmac_f32 v55, v32, v15
  v_fmac_f32 v62, v33, v14
  v_fmac_f32 v63, v33, v15
  buffer_load_dwordx4 v[108:111], v5, s[20:23], s46 offen offset:3072 nt
  s_waitcnt vmcnt(2)
  v_lshlrev_b32 v14, 16, v100
  v_and_b32 v15, 0xffff0000, v100
  v_fmac_f32 v48, v34, v14
  v_fmac_f32 v49, v34, v15
  v_fmac_f32 v56, v35, v14
  v_fmac_f32 v57, v35, v15
  v_lshlrev_b32 v14, 16, v101
  v_and_b32 v15, 0xffff0000, v101
  v_fmac_f32 v50, v34, v14
  v_fmac_f32 v51, v34, v15
  v_fmac_f32 v58, v35, v14
  v_fmac_f32 v59, v35, v15
  v_lshlrev_b32 v14, 16, v102
  v_and_b32 v15, 0xffff0000, v102
  v_fmac_f32 v52, v34, v14
  v_fmac_f32 v53, v34, v15
  v_fmac_f32 v60, v35, v14
  v_fmac_f32 v61, v35, v15
  v_lshlrev_b32 v14, 16, v103
  v_and_b32 v15, 0xffff0000, v103
  v_fmac_f32 v54, v34, v14
  v_fmac_f32 v55, v34, v15
  v_fmac_f32 v62, v35, v14
  v_fmac_f32 v63, v35, v15
  buffer_load_dwordx4 v[112:115], v5, s[20:23], s47 offen offset:0 nt
  s_waitcnt vmcnt(2)
  v_lshlrev_b32 v14, 16, v104
  v_and_b32 v15, 0xffff0000, v104
  v_fmac_f32 v48, v36, v14
  v_fmac_f32 v49, v36, v15
  v_fmac_f32 v56, v37, v14
  v_fmac_f32 v57, v37, v15
  v_lshlrev_b32 v14, 16, v105
  v_and_b32 v15, 0xffff0000, v105
  v_fmac_f32 v50, v36, v14
  v_fmac_f32 v51, v36, v15
  v_fmac_f32 v58, v37, v14
  v_fmac_f32 v59, v37, v15
  v_lshlrev_b32 v14, 16, v106
  v_and_b32 v15, 0xffff0000, v106
  v_fmac_f32 v52, v36, v14
  v_fmac_f32 v53, v36, v15
  v_fmac_f32 v60, v37, v14
  v_fmac_f32 v61, v37, v15
  v_lshlrev_b32 v14, 16, v107
  v_and_b32 v15, 0xffff0000, v107
  v_fmac_f32 v54, v36, v14
  v_fmac_f32 v55, v36, v15
  v_fmac_f32 v62, v37, v14
  v_fmac_f32 v63, v37, v15
  buffer_load_dwordx4 v[116:119], v5, s[20:23], s47 offen offset:1024 nt
  s_waitcnt vmcnt(2)
  v_lshlrev_b32 v14, 16, v108
  v_and_b32 v15, 0xffff0000, v108
  v_fmac_f32 v48, v38, v14
  v_fmac_f32 v49, v38, v15
  v_fmac_f32 v56, v39, v14
  v_fmac_f32 v57, v39, v15
  v_lshlrev_b32 v14, 16, v109
  v_and_b32 v15, 0xffff0000, v109
  v_fmac_f32 v50, v38, v14
  v_fmac_f32 v51, v38, v15
  v_fmac_f32 v58, v39, v14
  v_fmac_f32 v59, v39, v15
  v_lshlrev_b32 v14, 16, v110
  v_and_b32 v15, 0xffff0000, v110
  v_fmac_f32 v52, v38, v14
  v_fmac_f32 v53, v38, v15
  v_fmac_f32 v60, v39, v14
  v_fmac_f32 v61, v39, v15
  v_lshlrev_b32 v14, 16, v111
  v_and_b32 v15, 0xffff0000, v111
  v_fmac_f32 v54, v38, v14
  v_fmac_f32 v55, v38, v15
  v_fmac_f32 v62, v39, v14
  v_fmac_f32 v63, v39, v15
  buffer_load_dwordx4 v[120:123], v5, s[20:23], s47 offen offset:2048 nt
  s_waitcnt vmcnt(2)
  v_lshlrev_b32 v14, 16, v112
  v_and_b32 v15, 0xffff0000, v112
  v_fmac_f32 v48, v40, v14
  v_fmac_f32 v49, v40, v15
  v_fmac_f32 v56, v41, v14
  v_fmac_f32 v57, v41, v15
  v_lshlrev_b32 v14, 16, v113
  v_and_b32 v15, 0xffff0000, v113
  v_fmac_f32 v50, v40, v14
  v_fmac_f32 v51, v40, v15
  v_fmac_f32 v58, v41, v14
  v_fmac_f32 v59, v41, v15
  v_lshlrev_b32 v14, 16, v114
  v_and_b32 v15, 0xffff0000, v114
  v_fmac_f32 v52, v40, v14
  v_fmac_f32 v53, v40, v15
  v_fmac_f32 v60, v41, v14
  v_fmac_f32 v61, v41, v15
  v_lshlrev_b32 v14, 16, v115
  v_and_b32 v15, 0xffff0000, v115
  v_fmac_f32 v54, v40, v14
  v_fmac_f32 v55, v40, v15
  v_fmac_f32 v62, v41, v14
  v_fmac_f32 v63, v41, v15
  buffer_load_dwordx4 v[124:127], v5, s[20:23], s47 offen offset:3072 nt
  s_waitcnt vmcnt(2)
  v_lshlrev_b32 v14, 16, v116
  v_and_b32 v15, 0xffff0000, v116
  v_fmac_f32 v48, v42, v14
  v_fmac_f32 v49, v42, v15
  v_fmac_f32 v56, v43, v14
  v_fmac_f32 v57, v43, v15
  v_lshlrev_b32 v14, 16, v117
  v_and_b32 v15, 0xffff0000, v117
  v_fmac_f32 v50, v42, v14
  v_fmac_f32 v51, v42, v15
  v_fmac_f32 v58, v43, v14
  v_fmac_f32 v59, v43, v15
  v_lshlrev_b32 v14, 16, v118
  v_and_b32 v15, 0xffff0000, v118
  v_fmac_f32 v52, v42, v14
  v_fmac_f32 v53, v42, v15
  v_fmac_f32 v60, v43, v14
  v_fmac_f32 v61, v43, v15
  v_lshlrev_b32 v14, 16, v119
  v_and_b32 v15, 0xffff0000, v119
  v_fmac_f32 v54, v42, v14
  v_fmac_f32 v55, v42, v15
  v_fmac_f32 v62, v43, v14
  v_fmac_f32 v63, v43, v15
  s_waitcnt vmcnt(1)
  v_lshlrev_b32 v14, 16, v120
  v_and_b32 v15, 0xffff0000, v120
  v_fmac_f32 v48, v44, v14
  v_fmac_f32 v49, v44, v15
  v_fmac_f32 v56, v45, v14
  v_fmac_f32 v57, v45, v15
  v_lshlrev_b32 v14, 16, v121
  v_and_b32 v15, 0xffff0000, v121
  v_fmac_f32 v50, v44, v14
  v_fmac_f32 v51, v44, v15
  v_fmac_f32 v58, v45, v14
  v_fmac_f32 v59, v45, v15
  v_lshlrev_b32 v14, 16, v122
  v_and_b32 v15, 0xffff0000, v122
  v_fmac_f32 v52, v44, v14
  v_fmac_f32 v53, v44, v15
  v_fmac_f32 v60, v45, v14
  v_fmac_f32 v61, v45, v15
  v_lshlrev_b32 v14, 16, v123
  v_and_b32 v15, 0xffff0000, v123
  v_fmac_f32 v54, v44, v14
  v_fmac_f32 v55, v44, v15
  v_fmac_f32 v62, v45, v14
  v_fmac_f32 v63, v45, v15
  s_waitcnt vmcnt(0)
  v_lshlrev_b32 v14, 16, v124
  v_and_b32 v15, 0xffff0000, v124
  v_fmac_f32 v48, v46, v14
  v_fmac_f32 v49, v46, v15
  v_fmac_f32 v56, v47, v14
  v_fmac_f32 v57, v47, v15
  v_lshlrev_b32 v14, 16, v125
  v_and_b32 v15, 0xffff0000, v125
  v_fmac_f32 v50, v46, v14
  v_fmac_f32 v51, v46, v15
  v_fmac_f32 v58, v47, v14
  v_fmac_f32 v59, v47, v15
  v_lshlrev_b32 v14, 16, v126
  v_and_b32 v15, 0xffff0000, v126
  v_fmac_f32 v52, v46, v14
  v_fmac_f32 v53, v46, v15
  v_fmac_f32 v60, v47, v14
  v_fmac_f32 v61, v47, v15
  v_lshlrev_b32 v14, 16, v127
  v_and_b32 v15, 0xffff0000, v127
  v_fmac_f32 v54, v46, v14
  v_fmac_f32 v55, v46, v15
  v_fmac_f32 v62, v47, v14
  v_fmac_f32 v63, v47, v15
  v_mov_b32 v64, v48
  v_mov_b32 v65, v49
  v_mov_b32 v66, v50
  v_mov_b32 v67, v51
  v_mov_b32 v68, v52
  v_mov_b32 v69, v53
  v_mov_b32 v70, v54
  v_mov_b32 v71, v55
  v_mov_b32 v72, v56
  v_mov_b32 v73, v57
  v_mov_b32 v74, v58
  v_mov_b32 v75, v59
  v_mov_b32 v76, v60
  v_mov_b32 v77, v61
  v_mov_b32 v78, v62
  v_mov_b32 v79, v63
  v_permlane16_swap_b32 v48, v64
  v_permlane16_swap_b32 v49, v65
  v_permlane16_swap_b32 v50, v66
  v_permlane16_swap_b32 v51, v67
  v_permlane16_swap_b32 v52, v68
  v_permlane16_swap_b32 v53, v69
  v_permlane16_swap_b32 v54, v70
  v_permlane16_swap_b32 v55, v71
  v_permlane16_swap_b32 v56, v72
  v_permlane16_swap_b32 v57, v73
  v_permlane16_swap_b32 v58, v74
  v_permlane16_swap_b32 v59, v75
  v_permlane16_swap_b32 v60, v76
  v_permlane16_swap_b32 v61, v77
  v_permlane16_swap_b32 v62, v78
  v_permlane16_swap_b32 v63, v79
  v_add_f32 v48, v48, v64
  v_add_f32 v49, v49, v65
  v_add_f32 v50, v50, v66
  v_add_f32 v51, v51, v67
  v_add_f32 v52, v52, v68
  v_add_f32 v53, v53, v69
  v_add_f32 v54, v54, v70
  v_add_f32 v55, v55, v71
  v_add_f32 v56, v56, v72
  v_add_f32 v57, v57, v73
  v_add_f32 v58, v58, v74
  v_add_f32 v59, v59, v75
  v_add_f32 v60, v60, v76
  v_add_f32 v61, v61, v77
  v_add_f32 v62, v62, v78
  v_add_f32 v63, v63, v79
  v_mov_b32 v64, v48
  v_mov_b32 v65, v49
  v_mov_b32 v66, v50
  v_mov_b32 v67, v51
  v_mov_b32 v68, v52
  v_mov_b32 v69, v53
  v_mov_b32 v70, v54
  v_mov_b32 v71, v55
  v_mov_b32 v72, v56
  v_mov_b32 v73, v57
  v_mov_b32 v74, v58
  v_mov_b32 v75, v59
  v_mov_b32 v76, v60
  v_mov_b32 v77, v61
  v_mov_b32 v78, v62
  v_mov_b32 v79, v63
  v_permlane32_swap_b32 v48, v64
  v_permlane32_swap_b32 v49, v65
  v_permlane32_swap_b32 v50, v66
  v_permlane32_swap_b32 v51, v67
  v_permlane32_swap_b32 v52, v68
  v_permlane32_swap_b32 v53, v69
  v_permlane32_swap_b32 v54, v70
  v_permlane32_swap_b32 v55, v71
  v_permlane32_swap_b32 v56, v72
  v_permlane32_swap_b32 v57, v73
  v_permlane32_swap_b32 v58, v74
  v_permlane32_swap_b32 v59, v75
  v_permlane32_swap_b32 v60, v76
  v_permlane32_swap_b32 v61, v77
  v_permlane32_swap_b32 v62, v78
  v_permlane32_swap_b32 v63, v79
  v_add_f32 v48, v48, v64
  v_add_f32 v49, v49, v65
  v_add_f32 v50, v50, v66
  v_add_f32 v51, v51, v67
  v_add_f32 v52, v52, v68
  v_add_f32 v53, v53, v69
  v_add_f32 v54, v54, v70
  v_add_f32 v55, v55, v71
  v_add_f32 v56, v56, v72
  v_add_f32 v57, v57, v73
  v_add_f32 v58, v58, v74
  v_add_f32 v59, v59, v75
  v_add_f32 v60, v60, v76
  v_add_f32 v61, v61, v77
  v_add_f32 v62, v62, v78
  v_add_f32 v63, v63, v79
  s_lshl_b32 s37, s3, 10
  v_lshlrev_b32 v7, 5, v4
  v_add_u32 v7, s37, v7
  s_lshl_b32 s37, s3, 4
  v_mov_b32 v6, s37
  s_mov_b64 exec, 0xffff
  ds_write_b128 v7, v[48:51] offset:2560
  ds_write_b128 v7, v[52:55] offset:2576
  ds_write_b128 v7, v[56:59] offset:3072
  ds_write_b128 v7, v[60:63] offset:3088
  ds_write_b128 v6, v[10:13] offset:2304
  s_mov_b64 exec, -1
  s_waitcnt lgkmcnt(0)
  v_mov_b32 v6, 16
  v_mov_b32 v7, 1
  s_mov_b64 exec, 1
  ds_add_rtn_u32 v7, v6, v7
  s_waitcnt lgkmcnt(0)
  s_mov_b64 exec, -1
  v_readfirstlane_b32 s32, v7
  s_nop 0
  s_cmp_lg_u32 s32, 7
  s_cbranch_scc1 L_A_done
  v_lshrrev_b32 v6, 5, v2
  v_lshlrev_b32 v7, 3, v6
  ds_read_b64 v[64:65], v7 offset:2304
  ds_read_b64 v[66:67], v7 offset:2320
  ds_read_b64 v[68:69], v7 offset:2336
  ds_read_b64 v[70:71], v7 offset:2352
  ds_read_b64 v[72:73], v7 offset:2368
  ds_read_b64 v[74:75], v7 offset:2384
  ds_read_b64 v[76:77], v7 offset:2400
  ds_read_b64 v[78:79], v7 offset:2416
  v_lshlrev_b32 v9, 4, v2
  ds_read_b128 v[20:23], v9 offset:2560
  ds_read_b128 v[24:27], v9 offset:3584
  ds_read_b128 v[28:31], v9 offset:4608
  ds_read_b128 v[32:35], v9 offset:5632
  ds_read_b128 v[36:39], v9 offset:6656
  ds_read_b128 v[40:43], v9 offset:7680
  ds_read_b128 v[44:47], v9 offset:8704
  ds_read_b128 v[48:51], v9 offset:9728
  s_waitcnt lgkmcnt(0)
  v_max_f32 v12, v64, v66
  v_max_f32 v12, v12, v68
  v_max_f32 v12, v12, v70
  v_max_f32 v12, v12, v72
  v_max_f32 v12, v12, v74
  v_max_f32 v12, v12, v76
  v_max_f32 v12, v12, v78
  v_sub_f32 v64, v64, v12
  v_sub_f32 v66, v66, v12
  v_sub_f32 v68, v68, v12
  v_sub_f32 v70, v70, v12
  v_sub_f32 v72, v72, v12
  v_sub_f32 v74, v74, v12
  v_sub_f32 v76, v76, v12
  v_sub_f32 v78, v78, v12
  v_exp_f32 v64, v64
  v_exp_f32 v66, v66
  v_exp_f32 v68, v68
  v_exp_f32 v70, v70
  v_exp_f32 v72, v72
  v_exp_f32 v74, v74
  v_exp_f32 v76, v76
  v_exp_f32 v78, v78
  v_mov_b32 v13, 0
  v_mov_b32 v16, 0
  v_mov_b32 v17, 0
  v_mov_b32 v18, 0
  v_mov_b32 v19, 0
  v_fmac_f32 v13, v64, v65
  v_fmac_f32 v16, v64, v20
  v_fmac_f32 v17, v64, v21
  v_fmac_f32 v18, v64, v22
  v_fmac_f32 v19, v64, v23
  v_fmac_f32 v13, v66, v67
  v_fmac_f32 v16, v66, v24
  v_fmac_f32 v17, v66, v25
  v_fmac_f32 v18, v66, v26
  v_fmac_f32 v19, v66, v27
  v_fmac_f32 v13, v68, v69
  v_fmac_f32 v16, v68, v28
  v_fmac_f32 v17, v68, v29
  v_fmac_f32 v18, v68, v30
  v_fmac_f32 v19, v68, v31
  v_fmac_f32 v13, v70, v71
  v_fmac_f32 v16, v70, v32
  v_fmac_f32 v17, v70, v33
  v_fmac_f32 v18, v70, v34
  v_fmac_f32 v19, v70, v35
  v_fmac_f32 v13, v72, v73
  v_fmac_f32 v16, v72, v36
  v_fmac_f32 v17, v72, v37
  v_fmac_f32 v18, v72, v38
  v_fmac_f32 v19, v72, v39
  v_fmac_f32 v13, v74, v75
  v_fmac_f32 v16, v74, v40
  v_fmac_f32 v17, v74, v41
  v_fmac_f32 v18, v74, v42
  v_fmac_f32 v19, v74, v43
  v_fmac_f32 v13, v76, v77
  v_fmac_f32 v16, v76, v44
  v_fmac_f32 v17, v76, v45
  v_fmac_f32 v18, v76, v46
  v_fmac_f32 v19, v76, v47
  v_fmac_f32 v13, v78, v79
  v_fmac_f32 v16, v78, v48
  v_fmac_f32 v17, v78, v49
  v_fmac_f32 v18, v78, v50
  v_fmac_f32 v19, v78, v51
  v_mov_b32 v24, v16
  v_mov_b32 v25, s39
  v_mov_b32 v26, v17
  v_mov_b32 v27, s39
  v_mov_b32 v28, v18
  v_mov_b32 v29, s39
  v_mov_b32 v30, v19
  v_mov_b32 v31, s39
  s_lshl_b32 s34, s2, 11
  s_add_u32 s34, s34, 720896
  v_lshlrev_b32 v9, 5, v2
  buffer_store_dwordx4 v[24:27], v9, s[4:7], s34 offen sc1
  buffer_store_dwordx4 v[28:31], v9, s[4:7], s34 offen offset:16 sc1
  s_nop 1
  v_mov_b32 v24, v12
  v_mov_b32 v26, v13
  s_lshl_b32 s34, s2, 5
  s_add_u32 s34, s34, 1245184
  v_lshlrev_b32 v7, 4, v6
  v_and_b32 v6, 31, v2
  v_cmp_eq_u32 vcc, 0, v6
  s_and_saveexec_b64 s[36:37], vcc
  buffer_store_dwordx4 v[24:27], v7, s[4:7], s34 offen sc1
  s_mov_b64 exec, s[36:37]
  s_lshl_b32 s33, s2, 7
  s_add_u32 s33, s33, 12845056
  v_mov_b32 v6, 0
  v_mov_b32 v7, s39
  s_mov_b64 exec, 1
  buffer_store_dword v7, v6, s[4:7], s33 offen sc1
  s_mov_b64 exec, -1
L_A_done:
  s_sub_u32 s61, s2, 128
  s_cmp_lt_u32 s61, 32
  s_cbranch_scc1 L_A_tail
  s_endpgm
L_C:
  s_setprio 2
  s_load_dwordx4 s[84:87], s[0:1], 24
  s_load_dwordx8 s[88:95], s[0:1], 48
  s_load_dwordx4 s[96:99], s[0:1], 80
  s_load_dwordx2 s[100:101], s[0:1], 96
  s_sub_u32 s3, s3, 8
  s_waitcnt lgkmcnt(0)
  s_mov_b32 s4, s46
  s_and_b32 s5, s47, 0xffff
  s_mov_b32 s6, 13631488
  s_mov_b32 s7, 0x20000
  s_mov_b32 s8, s44
  s_and_b32 s9, s45, 0xffff
  s_mov_b32 s10, 256
  s_mov_b32 s11, 0x20000
  s_mov_b32 s12, s48
  s_and_b32 s13, s49, 0xffff
  s_mov_b32 s14, 2304
  s_mov_b32 s15, 0x20000
  s_lshr_b32 s32, s2, 7
  s_cmp_eq_u32 s32, 0
  s_cselect_b32 s50, s84, s90
  s_cselect_b32 s51, s85, s91
  s_mov_b32 s16, s50
  s_and_b32 s17, s51, 0xffff
  s_mov_b32 s18, 4718592
  s_mov_b32 s19, 0x20000
  s_mov_b32 s20, s92
  s_and_b32 s21, s93, 0xffff
  s_mov_b32 s22, 4194304
  s_mov_b32 s23, 0x20000
  s_mov_b32 s24, s88
  s_and_b32 s25, s89, 0xffff
  s_mov_b32 s26, 8388608
  s_mov_b32 s27, 0x20000
  s_or_b32 s32, s2, s3
  s_cmp_lg_u32 s32, 0
  s_cbranch_scc1 L_C_notag
  s_memrealtime s[60:61]
  s_waitcnt lgkmcnt(0)
  s_or_b32 s60, s60, 1
  v_mov_b32 v6, 0
  v_mov_b32 v7, s60
  s_mov_b64 exec, 1
  buffer_store_dword v7, v6, s[8:11], 0 offen sc1
  s_mov_b64 exec, -1
L_C_notag:
  s_and_b32 s33, s2, 3
  s_mul_i32 s33, s33, 144
  s_mul_i32 s34, s3, 18
  s_add_u32 s33, s33, s34
  v_lshrrev_b32 v5, 5, v2
  v_add_u32 v5, s33, v5
  v_lshlrev_b32 v7, 1, v5
  s_bfe_u32 s35, s2, 0x50002
  s_lshl_b32 s35, s35, 8
  v_lshlrev_b32 v6, 13, v5
  v_and_b32 v8, 31, v2
  v_lshl_add_u32 v6, v8, 3, v6
  v_add_u32 v6, s35, v6
  s_mov_b32 s36, 0
  buffer_load_dwordx2 v[16:17], v6, s[16:19], s36 offen nt
  s_add_u32 s36, s36, 16384
  buffer_load_dwordx2 v[18:19], v6, s[16:19], s36 offen nt
  s_add_u32 s36, s36, 16384
  buffer_load_dwordx2 v[20:21], v6, s[16:19], s36 offen nt
  s_add_u32 s36, s36, 16384
  buffer_load_dwordx2 v[22:23], v6, s[16:19], s36 offen nt
  s_add_u32 s36, s36, 16384
  buffer_load_dwordx2 v[24:25], v6, s[16:19], s36 offen nt
  s_add_u32 s36, s36, 16384
  buffer_load_dwordx2 v[26:27], v6, s[16:19], s36 offen nt
  s_add_u32 s36, s36, 16384
  buffer_load_dwordx2 v[28:29], v6, s[16:19], s36 offen nt
  s_add_u32 s36, s36, 16384
  buffer_load_dwordx2 v[30:31], v6, s[16:19], s36 offen nt
  s_add_u32 s36, s36, 16384
  buffer_load_dwordx2 v[32:33], v6, s[16:19], s36 offen nt
  buffer_load_ushort v40, v7, s[12:15], 0 offen offset:0
  buffer_load_ushort v41, v7, s[12:15], 0 offen offset:1152
  buffer_load_ushort v42, v7, s[12:15], 0 offen offset:4
  buffer_load_ushort v43, v7, s[12:15], 0 offen offset:1156
  buffer_load_ushort v44, v7, s[12:15], 0 offen offset:8
  buffer_load_ushort v45, v7, s[12:15], 0 offen offset:1160
  buffer_load_ushort v46, v7, s[12:15], 0 offen offset:12
  buffer_load_ushort v47, v7, s[12:15], 0 offen offset:1164
  buffer_load_ushort v48, v7, s[12:15], 0 offen offset:16
  buffer_load_ushort v49, v7, s[12:15], 0 offen offset:1168
  buffer_load_ushort v50, v7, s[12:15], 0 offen offset:20
  buffer_load_ushort v51, v7, s[12:15], 0 offen offset:1172
  buffer_load_ushort v52, v7, s[12:15], 0 offen offset:24
  buffer_load_ushort v53, v7, s[12:15], 0 offen offset:1176
  buffer_load_ushort v54, v7, s[12:15], 0 offen offset:28
  buffer_load_ushort v55, v7, s[12:15], 0 offen offset:1180
  buffer_load_ushort v56, v7, s[12:15], 0 offen offset:32
  buffer_load_ushort v57, v7, s[12:15], 0 offen offset:1184
  s_lshr_b32 s42, s2, 3
  s_and_b32 s43, s2, 7
  s_lshl_b32 s33, s43, 6
  s_lshl_b32 s34, s3, 3
  s_add_u32 s33, s33, s34
  v_add_u32 v9, s33, v3
  v_lshlrev_b32 v10, 13, v9
  s_lshl_b32 s34, s42, 8
  v_lshl_add_u32 v10, v4, 4, v10
  v_add_u32 v10, s34, v10
  s_mov_b32 s36, 32768
  buffer_load_dwordx4 v[64:67], v10, s[20:23], 0 offen nt
  buffer_load_dwordx4 v[68:71], v10, s[20:23], s36 offen nt
  s_barrier
  s_cmp_lg_u32 s3, 0
  s_cbranch_scc1 L_C_nt
L_tag_4:
  v_mov_b32 v12, 0
  buffer_load_dword v12, v12, s[8:11], 0 offen sc1
  s_waitcnt vmcnt(0)
  v_readfirstlane_b32 s39, v12
  s_add_u32 s62, s62, 1
  s_cmp_gt_u32 s62, 0x1000000
  s_cbranch_scc1 L_bail
  s_cmp_lg_u32 s39, 0
  s_cbranch_scc1 L_tag_4_d
  s_sleep 2
  s_branch L_tag_4
L_tag_4_d:
  v_mov_b32 v13, 192
  ds_write_b32 v13, v12
L_C_nt:
  s_waitcnt vmcnt(2)
  v_mov_b32 v12, 28
  v_mov_b32 v13, 1
  s_mov_b64 exec, 1
  ds_add_u32 v12, v13
  s_mov_b64 exec, -1
  v_lshlrev_b32 v40, 16, v40
  v_lshlrev_b32 v41, 16, v41
  v_lshlrev_b32 v42, 16, v42
  v_lshlrev_b32 v43, 16, v43
  v_lshlrev_b32 v44, 16, v44
  v_lshlrev_b32 v45, 16, v45
  v_lshlrev_b32 v46, 16, v46
  v_lshlrev_b32 v47, 16, v47
  v_lshlrev_b32 v48, 16, v48
  v_lshlrev_b32 v49, 16, v49
  v_lshlrev_b32 v50, 16, v50
  v_lshlrev_b32 v51, 16, v51
  v_lshlrev_b32 v52, 16, v52
  v_lshlrev_b32 v53, 16, v53
  v_lshlrev_b32 v54, 16, v54
  v_lshlrev_b32 v55, 16, v55
  v_lshlrev_b32 v56, 16, v56
  v_lshlrev_b32 v57, 16, v57
  v_mov_b32 v72, 0
  v_mov_b32 v73, 0
  v_mov_b32 v74, 0
  v_mov_b32 v75, 0
  v_mov_b32 v76, 0
  v_mov_b32 v77, 0
  v_mov_b32 v78, 0
  v_mov_b32 v79, 0
  v_lshlrev_b32 v12, 16, v16
  v_and_b32 v13, 0xffff0000, v16
  v_fmac_f32 v72, v40, v12
  v_fmac_f32 v73, v40, v13
  v_fmac_f32 v76, v41, v12
  v_fmac_f32 v77, v41, v13
  v_lshlrev_b32 v12, 16, v17
  v_and_b32 v13, 0xffff0000, v17
  v_fmac_f32 v74, v40, v12
  v_fmac_f32 v75, v40, v13
  v_fmac_f32 v78, v41, v12
  v_fmac_f32 v79, v41, v13
  v_lshlrev_b32 v12, 16, v18
  v_and_b32 v13, 0xffff0000, v18
  v_fmac_f32 v72, v42, v12
  v_fmac_f32 v73, v42, v13
  v_fmac_f32 v76, v43, v12
  v_fmac_f32 v77, v43, v13
  v_lshlrev_b32 v12, 16, v19
  v_and_b32 v13, 0xffff0000, v19
  v_fmac_f32 v74, v42, v12
  v_fmac_f32 v75, v42, v13
  v_fmac_f32 v78, v43, v12
  v_fmac_f32 v79, v43, v13
  v_lshlrev_b32 v12, 16, v20
  v_and_b32 v13, 0xffff0000, v20
  v_fmac_f32 v72, v44, v12
  v_fmac_f32 v73, v44, v13
  v_fmac_f32 v76, v45, v12
  v_fmac_f32 v77, v45, v13
  v_lshlrev_b32 v12, 16, v21
  v_and_b32 v13, 0xffff0000, v21
  v_fmac_f32 v74, v44, v12
  v_fmac_f32 v75, v44, v13
  v_fmac_f32 v78, v45, v12
  v_fmac_f32 v79, v45, v13
  v_lshlrev_b32 v12, 16, v22
  v_and_b32 v13, 0xffff0000, v22
  v_fmac_f32 v72, v46, v12
  v_fmac_f32 v73, v46, v13
  v_fmac_f32 v76, v47, v12
  v_fmac_f32 v77, v47, v13
  v_lshlrev_b32 v12, 16, v23
  v_and_b32 v13, 0xffff0000, v23
  v_fmac_f32 v74, v46, v12
  v_fmac_f32 v75, v46, v13
  v_fmac_f32 v78, v47, v12
  v_fmac_f32 v79, v47, v13
  v_lshlrev_b32 v12, 16, v24
  v_and_b32 v13, 0xffff0000, v24
  v_fmac_f32 v72, v48, v12
  v_fmac_f32 v73, v48, v13
  v_fmac_f32 v76, v49, v12
  v_fmac_f32 v77, v49, v13
  v_lshlrev_b32 v12, 16, v25
  v_and_b32 v13, 0xffff0000, v25
  v_fmac_f32 v74, v48, v12
  v_fmac_f32 v75, v48, v13
  v_fmac_f32 v78, v49, v12
  v_fmac_f32 v79, v49, v13
  v_lshlrev_b32 v12, 16, v26
  v_and_b32 v13, 0xffff0000, v26
  v_fmac_f32 v72, v50, v12
  v_fmac_f32 v73, v50, v13
  v_fmac_f32 v76, v51, v12
  v_fmac_f32 v77, v51, v13
  v_lshlrev_b32 v12, 16, v27
  v_and_b32 v13, 0xffff0000, v27
  v_fmac_f32 v74, v50, v12
  v_fmac_f32 v75, v50, v13
  v_fmac_f32 v78, v51, v12
  v_fmac_f32 v79, v51, v13
  v_lshlrev_b32 v12, 16, v28
  v_and_b32 v13, 0xffff0000, v28
  v_fmac_f32 v72, v52, v12
  v_fmac_f32 v73, v52, v13
  v_fmac_f32 v76, v53, v12
  v_fmac_f32 v77, v53, v13
  v_lshlrev_b32 v12, 16, v29
  v_and_b32 v13, 0xffff0000, v29
  v_fmac_f32 v74, v52, v12
  v_fmac_f32 v75, v52, v13
  v_fmac_f32 v78, v53, v12
  v_fmac_f32 v79, v53, v13
  v_lshlrev_b32 v12, 16, v30
  v_and_b32 v13, 0xffff0000, v30
  v_fmac_f32 v72, v54, v12
  v_fmac_f32 v73, v54, v13
  v_fmac_f32 v76, v55, v12
  v_fmac_f32 v77, v55, v13
  v_lshlrev_b32 v12, 16, v31
  v_and_b32 v13, 0xffff0000, v31
  v_fmac_f32 v74, v54, v12
  v_fmac_f32 v75, v54, v13
  v_fmac_f32 v78, v55, v12
  v_fmac_f32 v79, v55, v13
  v_lshlrev_b32 v12, 16, v32
  v_and_b32 v13, 0xffff0000, v32
  v_fmac_f32 v72, v56, v12
  v_fmac_f32 v73, v56, v13
  v_fmac_f32 v76, v57, v12
  v_fmac_f32 v77, v57, v13
  v_lshlrev_b32 v12, 16, v33
  v_and_b32 v13, 0xffff0000, v33
  v_fmac_f32 v74, v56, v12
  v_fmac_f32 v75, v56, v13
  v_fmac_f32 v78, v57, v12
  v_fmac_f32 v79, v57, v13
  s_lshl_b32 s33, s3, 1
  v_lshrrev_b32 v12, 5, v2
  v_add_u32 v12, s33, v12
  v_lshlrev_b32 v12, 10, v12
  v_lshl_add_u32 v12, v8, 4, v12
  v_add_u32 v12, 19456, v12
  ds_write_b128 v12, v[72:75]
  ds_write_b128 v12, v[76:79] offset:512
L_tag_5:
  v_mov_b32 v13, 192
  ds_read_b32 v13, v13
  s_waitcnt lgkmcnt(0)
  v_readfirstlane_b32 s39, v13
  s_add_u32 s62, s62, 1
  s_cmp_gt_u32 s62, 0x1000000
  s_cbranch_scc1 L_bail
  s_cmp_lg_u32 s39, 0
  s_cbranch_scc1 L_tag_5_d
  s_sleep 1
  s_branch L_tag_5
L_tag_5_d:
  s_waitcnt lgkmcnt(0)
  v_mov_b32 v12, 0
  v_mov_b32 v13, 1
  s_mov_b64 exec, 1
  ds_add_rtn_u32 v13, v12, v13
  s_waitcnt lgkmcnt(0)
  s_mov_b64 exec, -1
  v_readfirstlane_b32 s32, v13
  s_nop 0
  s_cmp_lg_u32 s32, 7
  s_cbranch_scc1 L_C_qdone
  v_lshlrev_b32 v12, 4, v2
  v_add_u32 v13, 19456, v12
  ds_read_b128 v[16:19], v13 offset:0
  ds_read_b128 v[20:23], v13 offset:1024
  ds_read_b128 v[24:27], v13 offset:2048
  ds_read_b128 v[28:31], v13 offset:3072
  ds_read_b128 v[32:35], v13 offset:4096
  ds_read_b128 v[36:39], v13 offset:5120
  ds_read_b128 v[40:43], v13 offset:6144
  ds_read_b128 v[44:47], v13 offset:7168
  s_waitcnt lgkmcnt(0)
  v_mov_b32 v48, v16
  v_mov_b32 v49, v17
  v_mov_b32 v50, v18
  v_mov_b32 v51, v19
  v_add_f32 v48, v48, v20
  v_add_f32 v49, v49, v21
  v_add_f32 v50, v50, v22
  v_add_f32 v51, v51, v23
  v_add_f32 v48, v48, v24
  v_add_f32 v49, v49, v25
  v_add_f32 v50, v50, v26
  v_add_f32 v51, v51, v27
  v_add_f32 v48, v48, v28
  v_add_f32 v49, v49, v29
  v_add_f32 v50, v50, v30
  v_add_f32 v51, v51, v31
  v_add_f32 v48, v48, v32
  v_add_f32 v49, v49, v33
  v_add_f32 v50, v50, v34
  v_add_f32 v51, v51, v35
  v_add_f32 v48, v48, v36
  v_add_f32 v49, v49, v37
  v_add_f32 v50, v50, v38
  v_add_f32 v51, v51, v39
  v_add_f32 v48, v48, v40
  v_add_f32 v49, v49, v41
  v_add_f32 v50, v50, v42
  v_add_f32 v51, v51, v43
  v_add_f32 v48, v48, v44
  v_add_f32 v49, v49, v45
  v_add_f32 v50, v50, v46
  v_add_f32 v51, v51, v47
  ds_read_b128 v[16:19], v13 offset:8192
  ds_read_b128 v[20:23], v13 offset:9216
  ds_read_b128 v[24:27], v13 offset:10240
  ds_read_b128 v[28:31], v13 offset:11264
  ds_read_b128 v[32:35], v13 offset:12288
  ds_read_b128 v[36:39], v13 offset:13312
  ds_read_b128 v[40:43], v13 offset:14336
  ds_read_b128 v[44:47], v13 offset:15360
  s_waitcnt lgkmcnt(0)
  v_add_f32 v48, v48, v16
  v_add_f32 v49, v49, v17
  v_add_f32 v50, v50, v18
  v_add_f32 v51, v51, v19
  v_add_f32 v48, v48, v20
  v_add_f32 v49, v49, v21
  v_add_f32 v50, v50, v22
  v_add_f32 v51, v51, v23
  v_add_f32 v48, v48, v24
  v_add_f32 v49, v49, v25
  v_add_f32 v50, v50, v26
  v_add_f32 v51, v51, v27
  v_add_f32 v48, v48, v28
  v_add_f32 v49, v49, v29
  v_add_f32 v50, v50, v30
  v_add_f32 v51, v51, v31
  v_add_f32 v48, v48, v32
  v_add_f32 v49, v49, v33
  v_add_f32 v50, v50, v34
  v_add_f32 v51, v51, v35
  v_add_f32 v48, v48, v36
  v_add_f32 v49, v49, v37
  v_add_f32 v50, v50, v38
  v_add_f32 v51, v51, v39
  v_add_f32 v48, v48, v40
  v_add_f32 v49, v49, v41
  v_add_f32 v50, v50, v42
  v_add_f32 v51, v51, v43
  v_add_f32 v48, v48, v44
  v_add_f32 v49, v49, v45
  v_add_f32 v50, v50, v46
  v_add_f32 v51, v51, v47
  s_lshl_b32 s34, s2, 11
  s_add_u32 s34, s34, 65536
  v_lshlrev_b32 v12, 5, v2
  v_mov_b32 v16, v48
  v_mov_b32 v17, s39
  v_mov_b32 v18, v49
  v_mov_b32 v19, s39
  v_mov_b32 v20, v50
  v_mov_b32 v21, s39
  v_mov_b32 v22, v51
  v_mov_b32 v23, s39
  buffer_store_dwordx4 v[16:19], v12, s[4:7], s34 offen sc1
  buffer_store_dwordx4 v[20:23], v12, s[4:7], s34 offen offset:16 sc1
L_C_qdone:
  s_cmp_lg_u32 s3, 0
  s_cbranch_scc1 L_C_w1
  s_bfe_u32 s35, s2, 0x40003
  s_lshr_b32 s36, s2, 7
  s_lshl_b32 s34, s35, 14
  s_lshl_b32 s37, s36, 10
  s_add_u32 s34, s34, s37
  s_add_u32 s34, s34, 65536
  v_lshrrev_b32 v12, 5, v2
  v_lshlrev_b32 v12, 13, v12
  v_and_b32 v13, 31, v2
  v_lshl_add_u32 v12, v13, 5, v12
  s_add_u32 s35, s42, 32
  s_lshl_b32 s35, s35, 13
  s_add_u32 s35, s35, 65536
  v_lshlrev_b32 v15, 5, v2
  s_add_u32 s36, s34, 4096
  s_add_u32 s37, s35, 4096
L_tl_6:
  buffer_load_dwordx4 v[16:19], v12, s[4:7], s34 offen offset:0 sc1
  buffer_load_dwordx4 v[20:23], v12, s[4:7], s34 offen offset:16 sc1
  buffer_load_dwordx4 v[24:27], v12, s[4:7], s34 offen offset:2048 sc1
  buffer_load_dwordx4 v[28:31], v12, s[4:7], s34 offen offset:2064 sc1
  buffer_load_dwordx4 v[32:35], v12, s[4:7], s36 offen offset:0 sc1
  buffer_load_dwordx4 v[36:39], v12, s[4:7], s36 offen offset:16 sc1
  buffer_load_dwordx4 v[40:43], v12, s[4:7], s36 offen offset:2048 sc1
  buffer_load_dwordx4 v[44:47], v12, s[4:7], s36 offen offset:2064 sc1
  buffer_load_dwordx4 v[72:75], v15, s[4:7], s35 offen offset:0 sc1
  buffer_load_dwordx4 v[76:79], v15, s[4:7], s35 offen offset:16 sc1
  buffer_load_dwordx4 v[80:83], v15, s[4:7], s35 offen offset:2048 sc1
  buffer_load_dwordx4 v[84:87], v15, s[4:7], s35 offen offset:2064 sc1
  buffer_load_dwordx4 v[88:91], v15, s[4:7], s37 offen offset:0 sc1
  buffer_load_dwordx4 v[92:95], v15, s[4:7], s37 offen offset:16 sc1
  buffer_load_dwordx4 v[96:99], v15, s[4:7], s37 offen offset:2048 sc1
  buffer_load_dwordx4 v[100:103], v15, s[4:7], s37 offen offset:2064 sc1
  s_waitcnt vmcnt(0)
  v_mov_b32 v48, s39
  v_mov_b32 v49, s39
  v_min3_u32 v48, v48, v17, v21
  v_max3_u32 v49, v49, v17, v21
  v_min3_u32 v48, v48, v25, v29
  v_max3_u32 v49, v49, v25, v29
  v_min3_u32 v48, v48, v33, v37
  v_max3_u32 v49, v49, v33, v37
  v_min3_u32 v48, v48, v41, v45
  v_max3_u32 v49, v49, v41, v45
  v_min3_u32 v48, v48, v19, v23
  v_max3_u32 v49, v49, v19, v23
  v_min3_u32 v48, v48, v27, v31
  v_max3_u32 v49, v49, v27, v31
  v_min3_u32 v48, v48, v35, v39
  v_max3_u32 v49, v49, v35, v39
  v_min3_u32 v48, v48, v43, v47
  v_max3_u32 v49, v49, v43, v47
  v_min3_u32 v48, v48, v73, v77
  v_max3_u32 v49, v49, v73, v77
  v_min3_u32 v48, v48, v81, v85
  v_max3_u32 v49, v49, v81, v85
  v_min3_u32 v48, v48, v89, v93
  v_max3_u32 v49, v49, v89, v93
  v_min3_u32 v48, v48, v97, v101
  v_max3_u32 v49, v49, v97, v101
  v_min3_u32 v48, v48, v75, v79
  v_max3_u32 v49, v49, v75, v79
  v_min3_u32 v48, v48, v83, v87
  v_max3_u32 v49, v49, v83, v87
  v_min3_u32 v48, v48, v91, v95
  v_max3_u32 v49, v49, v91, v95
  v_min3_u32 v48, v48, v99, v103
  v_max3_u32 v49, v49, v99, v103
  v_cmp_ne_u32 vcc, v48, v49
  s_cbranch_vccz L_tl_6_d
  s_add_u32 s62, s62, 1
  s_cmp_gt_u32 s62, 0x1000000
  s_cbranch_scc1 L_bail
  s_sleep 2
  s_branch L_tl_6
L_tl_6_d:
  v_add_f32 v48, v16, v24
  v_add_f32 v48, v48, v32
  v_add_f32 v48, v48, v40
  v_add_f32 v49, v18, v26
  v_add_f32 v49, v49, v34
  v_add_f32 v49, v49, v42
  v_add_f32 v50, v20, v28
  v_add_f32 v50, v50, v36
  v_add_f32 v50, v50, v44
  v_add_f32 v51, v22, v30
  v_add_f32 v51, v51, v38
  v_add_f32 v51, v51, v46
  v_add_f32 v52, v72, v80
  v_add_f32 v52, v52, v88
  v_add_f32 v52, v52, v96
  v_add_f32 v53, v74, v82
  v_add_f32 v53, v53, v90
  v_add_f32 v53, v53, v98
  v_add_f32 v54, v76, v84
  v_add_f32 v54, v54, v92
  v_add_f32 v54, v54, v100
  v_add_f32 v55, v78, v86
  v_add_f32 v55, v55, v94
  v_add_f32 v55, v55, v102
  v_cvt_pk_bf16_f32 v32, v48, v49
  v_cvt_pk_bf16_f32 v33, v50, v51
  v_lshlrev_b32 v12, 3, v2
  ds_write_b64 v12, v[32:33] offset:256
  v_cvt_pk_bf16_f32 v20, v52, v53
  v_cvt_pk_bf16_f32 v21, v54, v55
  v_lshlrev_b32 v16, 16, v20
  v_and_b32 v17, 0xffff0000, v20
  v_lshlrev_b32 v18, 16, v21
  v_and_b32 v19, 0xffff0000, v21
  v_lshlrev_b32 v12, 4, v2
  ds_write_b128 v12, v[16:19] offset:768
  s_waitcnt lgkmcnt(0)
  v_mov_b32 v12, 128
  v_mov_b32 v13, 1
  ds_write_b32 v12, v13
L_C_w1:
  v_mov_b32 v12, 128
L_lw_7:
  ds_read_b32 v13, v12
  s_waitcnt lgkmcnt(0)
  v_readfirstlane_b32 s32, v13
  s_nop 0
  s_cmp_lg_u32 s32, 0
  s_cbranch_scc1 L_lw_7_d
  s_add_u32 s62, s62, 1
  s_cmp_gt_u32 s62, 0x1000000
  s_cbranch_scc1 L_bail
  s_sleep 1
  s_branch L_lw_7
L_lw_7_d:
  v_lshlrev_b32 v13, 5, v4
  ds_read_b128 v[32:35], v13 offset:768
  ds_read_b128 v[36:39], v13 offset:784
  ds_read_b128 v[40:43], v13 offset:1280
  ds_read_b128 v[44:47], v13 offset:1296
  v_mov_b32 v48, 0
  v_mov_b32 v49, 0
  v_mov_b32 v50, 0
  v_mov_b32 v51, 0
  s_waitcnt lgkmcnt(0)
  v_lshlrev_b32 v12, 16, v64
  v_and_b32 v13, 0xffff0000, v64
  v_fmac_f32 v48, v32, v12
  v_fmac_f32 v48, v33, v13
  v_fmac_f32 v49, v40, v12
  v_fmac_f32 v49, v41, v13
  v_lshlrev_b32 v12, 16, v65
  v_and_b32 v13, 0xffff0000, v65
  v_fmac_f32 v48, v34, v12
  v_fmac_f32 v48, v35, v13
  v_fmac_f32 v49, v42, v12
  v_fmac_f32 v49, v43, v13
  v_lshlrev_b32 v12, 16, v66
  v_and_b32 v13, 0xffff0000, v66
  v_fmac_f32 v48, v36, v12
  v_fmac_f32 v48, v37, v13
  v_fmac_f32 v49, v44, v12
  v_fmac_f32 v49, v45, v13
  v_lshlrev_b32 v12, 16, v67
  v_and_b32 v13, 0xffff0000, v67
  v_fmac_f32 v48, v38, v12
  v_fmac_f32 v48, v39, v13
  v_fmac_f32 v49, v46, v12
  v_fmac_f32 v49, v47, v13
  v_lshlrev_b32 v12, 16, v68
  v_and_b32 v13, 0xffff0000, v68
  v_fmac_f32 v50, v32, v12
  v_fmac_f32 v50, v33, v13
  v_fmac_f32 v51, v40, v12
  v_fmac_f32 v51, v41, v13
  v_lshlrev_b32 v12, 16, v69
  v_and_b32 v13, 0xffff0000, v69
  v_fmac_f32 v50, v34, v12
  v_fmac_f32 v50, v35, v13
  v_fmac_f32 v51, v42, v12
  v_fmac_f32 v51, v43, v13
  v_lshlrev_b32 v12, 16, v70
  v_and_b32 v13, 0xffff0000, v70
  v_fmac_f32 v50, v36, v12
  v_fmac_f32 v50, v37, v13
  v_fmac_f32 v51, v44, v12
  v_fmac_f32 v51, v45, v13
  v_lshlrev_b32 v12, 16, v71
  v_and_b32 v13, 0xffff0000, v71
  v_fmac_f32 v50, v38, v12
  v_fmac_f32 v50, v39, v13
  v_fmac_f32 v51, v46, v12
  v_fmac_f32 v51, v47, v13
  s_nop 1
  v_add_f32_dpp v48, v48, v48 row_ror:8 row_mask:0xf bank_mask:0xf
  v_add_f32_dpp v49, v49, v49 row_ror:8 row_mask:0xf bank_mask:0xf
  v_add_f32_dpp v50, v50, v50 row_ror:8 row_mask:0xf bank_mask:0xf
  v_add_f32_dpp v51, v51, v51 row_ror:8 row_mask:0xf bank_mask:0xf
  v_add_f32_dpp v48, v48, v48 row_ror:4 row_mask:0xf bank_mask:0xf
  v_add_f32_dpp v49, v49, v49 row_ror:4 row_mask:0xf bank_mask:0xf
  v_add_f32_dpp v50, v50, v50 row_ror:4 row_mask:0xf bank_mask:0xf
  v_add_f32_dpp v51, v51, v51 row_ror:4 row_mask:0xf bank_mask:0xf
  v_add_f32_dpp v48, v48, v48 row_ror:2 row_mask:0xf bank_mask:0xf
  v_add_f32_dpp v49, v49, v49 row_ror:2 row_mask:0xf bank_mask:0xf
  v_add_f32_dpp v50, v50, v50 row_ror:2 row_mask:0xf bank_mask:0xf
  v_add_f32_dpp v51, v51, v51 row_ror:2 row_mask:0xf bank_mask:0xf
  v_add_f32_dpp v48, v48, v48 row_ror:1 row_mask:0xf bank_mask:0xf
  v_add_f32_dpp v49, v49, v49 row_ror:1 row_mask:0xf bank_mask:0xf
  v_add_f32_dpp v50, v50, v50 row_ror:1 row_mask:0xf bank_mask:0xf
  v_add_f32_dpp v51, v51, v51 row_ror:1 row_mask:0xf bank_mask:0xf
  v_cmp_eq_u32 vcc, 1, v4
  s_nop 1
  v_cndmask_b32 v48, v48, v49, vcc
  v_cmp_eq_u32 vcc, 2, v4
  s_nop 1
  v_cndmask_b32 v48, v48, v50, vcc
  v_cmp_eq_u32 vcc, 3, v4
  s_nop 1
  v_cndmask_b32 v48, v48, v51, vcc
  v_cvt_pk_bf16_f32 v48, v48, v48
  v_and_b32 v12, 1, v4
  v_lshlrev_b32 v12, 7, v12
  v_lshrrev_b32 v13, 1, v4
  v_lshl_add_u32 v13, v13, 2, v3
  s_lshl_b32 s34, s3, 3
  v_add_u32 v13, s34, v13
  v_lshl_add_u32 v12, v13, 1, v12
  s_mov_b32 exec_lo, 0x000f000f
  s_mov_b32 exec_hi, 0x000f000f
  ds_write_b16 v12, v48 offset:1792
  s_mov_b64 exec, -1
  s_mov_b32 s20, s94
  s_and_b32 s21, s95, 0xffff
  s_mov_b32 s22, 4194304
  s_mov_b32 s23, 0x20000
  s_mov_b32 s36, 32768
  buffer_load_dwordx4 v[64:67], v10, s[20:23], 0 offen nt
  buffer_load_dwordx4 v[68:71], v10, s[20:23], s36 offen nt
  s_waitcnt lgkmcnt(0)
  v_mov_b32 v12, 4
  v_mov_b32 v13, 1
  s_mov_b64 exec, 1
  ds_add_rtn_u32 v13, v12, v13
  s_waitcnt lgkmcnt(0)
  s_mov_b64 exec, -1
  v_readfirstlane_b32 s32, v13
  s_nop 0
  s_cmp_lg_u32 s32, 7
  s_cbranch_scc1 L_C_udone
  v_lshlrev_b32 v12, 3, v2
  ds_read_b64 v[16:17], v12 offset:1792
  v_lshrrev_b32 v13, 4, v2
  v_lshlrev_b32 v13, 16, v13
  v_lshl_add_u32 v12, v4, 4, v13
  s_lshl_b32 s34, s42, 11
  s_lshl_b32 s35, s43, 8
  s_add_u32 s34, s34, s35
  s_add_u32 s34, s34, 589824
  s_waitcnt lgkmcnt(0)
  v_mov_b32 v18, v17
  v_mov_b32 v17, s39
  v_mov_b32 v19, s39
  s_mov_b32 exec_lo, -1
  s_mov_b32 exec_hi, 0
  buffer_store_dwordx4 v[16:19], v12, s[4:7], s34 offen sc1
  s_mov_b64 exec, -1
  s_lshl_b32 s33, s2, 7
  s_add_u32 s33, s33, 12648448
  v_mov_b32 v12, 0
  v_mov_b32 v13, s39
  s_mov_b64 exec, 1
  buffer_store_dword v13, v12, s[4:7], s33 offen sc1
  s_mov_b64 exec, -1
L_C_udone:
  s_cmp_ge_u32 s2, 128
  s_cbranch_scc1 L_C_nockv
  s_lshl_b32 s33, s2, 16
  s_lshl_b32 s34, s3, 13
  s_add_u32 s33, s33, s34
  v_lshlrev_b32 v11, 4, v2
  s_mul_i32 s34, s3, 8448
  s_add_u32 s34, s34, 85504
  s_mov_b32 m0, s34
  s_nop 0
  buffer_load_dwordx4 v11, s[24:27], s33 offen nt lds
  s_add_u32 s33, s33, 1024
  s_add_u32 s34, s34, 1056
  s_mov_b32 m0, s34
  s_nop 0
  buffer_load_dwordx4 v11, s[24:27], s33 offen nt lds
  s_add_u32 s33, s33, 1024
  s_add_u32 s34, s34, 1056
  s_mov_b32 m0, s34
  s_nop 0
  buffer_load_dwordx4 v11, s[24:27], s33 offen nt lds
  s_add_u32 s33, s33, 1024
  s_add_u32 s34, s34, 1056
  s_mov_b32 m0, s34
  s_nop 0
  buffer_load_dwordx4 v11, s[24:27], s33 offen nt lds
  s_add_u32 s33, s33, 1024
  s_add_u32 s34, s34, 1056
  s_mov_b32 m0, s34
  s_nop 0
  buffer_load_dwordx4 v11, s[24:27], s33 offen nt lds
  s_add_u32 s33, s33, 1024
  s_add_u32 s34, s34, 1056
  s_mov_b32 m0, s34
  s_nop 0
  buffer_load_dwordx4 v11, s[24:27], s33 offen nt lds
  s_add_u32 s33, s33, 1024
  s_add_u32 s34, s34, 1056
  s_mov_b32 m0, s34
  s_nop 0
  buffer_load_dwordx4 v11, s[24:27], s33 offen nt lds
  s_add_u32 s33, s33, 1024
  s_add_u32 s34, s34, 1056
  s_mov_b32 m0, s34
  s_nop 0
  buffer_load_dwordx4 v11, s[24:27], s33 offen nt lds
L_C_nockv:
  s_cmp_ge_u32 s2, 128
  s_cbranch_scc1 L_C_noB
  s_cmp_lg_u32 s3, 0
  s_cbranch_scc1 L_C_w2
  s_mov_b32 s34, 12648448
  v_lshlrev_b32 v12, 7, v2
  s_add_u32 s51, s34, 8192
  s_add_u32 s52, s34, 16384
  s_add_u32 s53, s34, 24576
L_poll_8:
  buffer_load_dword v16, v12, s[4:7], s34 offen sc1
  buffer_load_dword v17, v12, s[4:7], s51 offen sc1
  buffer_load_dword v18, v12, s[4:7], s52 offen sc1
  buffer_load_dword v19, v12, s[4:7], s53 offen sc1
  s_waitcnt vmcnt(0)
  v_cmp_ne_u32 vcc, s39, v16
  v_cmp_ne_u32 s[36:37], s39, v17
  s_or_b64 vcc, vcc, s[36:37]
  v_cmp_ne_u32 s[36:37], s39, v18
  s_or_b64 vcc, vcc, s[36:37]
  v_cmp_ne_u32 s[36:37], s39, v19
  s_or_b64 vcc, vcc, s[36:37]
  s_cbranch_vccz L_poll_8_d
  s_add_u32 s62, s62, 1
  s_cmp_gt_u32 s62, 0x1000000
  s_cbranch_scc1 L_bail
  s_sleep 2
  s_branch L_poll_8
L_poll_8_d:
  s_mov_b64 exec, -1
  s_waitcnt lgkmcnt(0)
  v_mov_b32 v12, 132
  v_mov_b32 v13, 1
  ds_write_b32 v12, v13
L_C_w2:
  v_mov_b32 v12, 132
L_lw_9:
  ds_read_b32 v13, v12
  s_waitcnt lgkmcnt(0)
  v_readfirstlane_b32 s32, v13
  s_nop 0
  s_cmp_lg_u32 s32, 0
  s_cbranch_scc1 L_lw_9_d
  s_add_u32 s62, s62, 1
  s_cmp_gt_u32 s62, 0x1000000
  s_cbranch_scc1 L_bail
  s_sleep 1
  s_branch L_lw_9
L_lw_9_d:
  s_lshr_b32 s33, s2, 6
  s_lshl_b32 s34, s33, 16
  s_lshl_b32 s35, s3, 13
  s_add_u32 s34, s34, s35
  s_add_u32 s34, s34, 589824
  s_add_u32 s35, s34, 4096
  v_lshlrev_b32 v12, 4, v2
L_tl_10:
  buffer_load_dwordx4 v[16:19], v12, s[4:7], s34 offen offset:0 sc1
  buffer_load_dwordx4 v[20:23], v12, s[4:7], s34 offen offset:1024 sc1
  buffer_load_dwordx4 v[24:27], v12, s[4:7], s34 offen offset:2048 sc1
  buffer_load_dwordx4 v[28:31], v12, s[4:7], s34 offen offset:3072 sc1
  buffer_load_dwordx4 v[32:35], v12, s[4:7], s35 offen offset:0 sc1
  buffer_load_dwordx4 v[36:39], v12, s[4:7], s35 offen offset:1024 sc1
  buffer_load_dwordx4 v[40:43], v12, s[4:7], s35 offen offset:2048 sc1
  buffer_load_dwordx4 v[44:47], v12, s[4:7], s35 offen offset:3072 sc1
  s_waitcnt vmcnt(0)
  v_mov_b32 v48, s39
  v_mov_b32 v49, s39
  v_min3_u32 v48, v48, v17, v21
  v_max3_u32 v49, v49, v17, v21
  v_min3_u32 v48, v48, v25, v29
  v_max3_u32 v49, v49, v25, v29
  v_min3_u32 v48, v48, v33, v37
  v_max3_u32 v49, v49, v33, v37
  v_min3_u32 v48, v48, v41, v45
  v_max3_u32 v49, v49, v41, v45
  v_min3_u32 v48, v48, v19, v23
  v_max3_u32 v49, v49, v19, v23
  v_min3_u32 v48, v48, v27, v31
  v_max3_u32 v49, v49, v27, v31
  v_min3_u32 v48, v48, v35, v39
  v_max3_u32 v49, v49, v35, v39
  v_min3_u32 v48, v48, v43, v47
  v_max3_u32 v49, v49, v43, v47
  v_cmp_ne_u32 vcc, v48, v49
  s_cbranch_vccz L_tl_10_d
  s_add_u32 s62, s62, 1
  s_cmp_gt_u32 s62, 0x1000000
  s_cbranch_scc1 L_bail
  s_sleep 2
  s_branch L_tl_10
L_tl_10_d:
  s_mul_i32 s35, s3, 4160
  s_add_u32 s35, s35, 44032
  v_lshlrev_b32 v13, 3, v2
  v_add_u32 v13, s35, v13
  v_mov_b32 v17, v18
  v_mov_b32 v21, v22
  v_mov_b32 v25, v26
  v_mov_b32 v29, v30
  v_mov_b32 v33, v34
  v_mov_b32 v37, v38
  v_mov_b32 v41, v42
  v_mov_b32 v45, v46
  ds_write_b64 v13, v[16:17] offset:0
  ds_write_b64 v13, v[20:21] offset:512
  ds_write_b64 v13, v[24:25] offset:1040
  ds_write_b64 v13, v[28:29] offset:1552
  ds_write_b64 v13, v[32:33] offset:2080
  ds_write_b64 v13, v[36:37] offset:2592
  ds_write_b64 v13, v[40:41] offset:3120
  ds_write_b64 v13, v[44:45] offset:3632
  s_waitcnt lgkmcnt(0)
  v_mov_b32 v12, 64
  v_mov_b32 v13, 1
  s_mov_b64 exec, 1
  ds_add_u32 v12, v13
  s_mov_b64 exec, -1
L_cbar_11:
  ds_read_b32 v13, v12
  s_waitcnt lgkmcnt(0)
  v_readfirstlane_b32 s32, v13
  s_nop 0
  s_cmp_ge_u32 s32, 8
  s_cbranch_scc1 L_cbar_11_d
  s_add_u32 s62, s62, 1
  s_cmp_gt_u32 s62, 0x1000000
  s_cbranch_scc1 L_bail
  s_sleep 0
  s_branch L_cbar_11
L_cbar_11_d:
  s_lshr_b32 s35, s3, 2
  s_and_b32 s36, s3, 3
  s_lshl_b32 s37, s36, 4
  v_add_u32 v12, s37, v4
  v_mul_u32_u24 v12, 1056, v12
  v_lshl_add_u32 v12, v3, 4, v12
  v_add_u32 v12, 85504, v12
  s_lshl_b32 s37, s35, 4
  v_add_u32 v13, s37, v4
  v_mul_u32_u24 v13, 1040, v13
  v_lshl_add_u32 v13, v3, 4, v13
  v_add_u32 v13, 44032, v13
  v_mov_b32 v24, 0
  v_mov_b32 v25, 0
  v_mov_b32 v26, 0
  v_mov_b32 v27, 0
  ds_read_b128 v[28:31], v12 offset:0
  ds_read_b128 v[72:75], v13 offset:0
  ds_read_b128 v[32:35], v12 offset:64
  ds_read_b128 v[76:79], v13 offset:64
  ds_read_b128 v[36:39], v12 offset:128
  ds_read_b128 v[80:83], v13 offset:128
  ds_read_b128 v[40:43], v12 offset:192
  ds_read_b128 v[84:87], v13 offset:192
  ds_read_b128 v[44:47], v12 offset:256
  ds_read_b128 v[88:91], v13 offset:256
  ds_read_b128 v[48:51], v12 offset:320
  ds_read_b128 v[92:95], v13 offset:320
  ds_read_b128 v[52:55], v12 offset:384
  ds_read_b128 v[96:99], v13 offset:384
  ds_read_b128 v[56:59], v12 offset:448
  ds_read_b128 v[100:103], v13 offset:448
  s_waitcnt lgkmcnt(0)
  v_mfma_f32_16x16x32_bf16 v[24:27], v[28:31], v[72:75], v[24:27]
  v_mfma_f32_16x16x32_bf16 v[24:27], v[32:35], v[76:79], v[24:27]
  v_mfma_f32_16x16x32_bf16 v[24:27], v[36:39], v[80:83], v[24:27]
  v_mfma_f32_16x16x32_bf16 v[24:27], v[40:43], v[84:87], v[24:27]
  v_mfma_f32_16x16x32_bf16 v[24:27], v[44:47], v[88:91], v[24:27]
  v_mfma_f32_16x16x32_bf16 v[24:27], v[48:51], v[92:95], v[24:27]
  v_mfma_f32_16x16x32_bf16 v[24:27], v[52:55], v[96:99], v[24:27]
  v_mfma_f32_16x16x32_bf16 v[24:27], v[56:59], v[100:103], v[24:27]
  s_nop 3
  ds_read_b128 v[28:31], v12 offset:512
  ds_read_b128 v[72:75], v13 offset:512
  ds_read_b128 v[32:35], v12 offset:576
  ds_read_b128 v[76:79], v13 offset:576
  ds_read_b128 v[36:39], v12 offset:640
  ds_read_b128 v[80:83], v13 offset:640
  ds_read_b128 v[40:43], v12 offset:704
  ds_read_b128 v[84:87], v13 offset:704
  ds_read_b128 v[44:47], v12 offset:768
  ds_read_b128 v[88:91], v13 offset:768
  ds_read_b128 v[48:51], v12 offset:832
  ds_read_b128 v[92:95], v13 offset:832
  ds_read_b128 v[52:55], v12 offset:896
  ds_read_b128 v[96:99], v13 offset:896
  ds_read_b128 v[56:59], v12 offset:960
  ds_read_b128 v[100:103], v13 offset:960
  s_waitcnt lgkmcnt(0)
  v_mfma_f32_16x16x32_bf16 v[24:27], v[28:31], v[72:75], v[24:27]
  v_mfma_f32_16x16x32_bf16 v[24:27], v[32:35], v[76:79], v[24:27]
  v_mfma_f32_16x16x32_bf16 v[24:27], v[36:39], v[80:83], v[24:27]
  v_mfma_f32_16x16x32_bf16 v[24:27], v[40:43], v[84:87], v[24:27]
  v_mfma_f32_16x16x32_bf16 v[24:27], v[44:47], v[88:91], v[24:27]
  v_mfma_f32_16x16x32_bf16 v[24:27], v[48:51], v[92:95], v[24:27]
  v_mfma_f32_16x16x32_bf16 v[24:27], v[52:55], v[96:99], v[24:27]
  v_mfma_f32_16x16x32_bf16 v[24:27], v[56:59], v[100:103], v[24:27]
  s_nop 3
  s_nop 8
  s_lshl_b32 s37, s35, 12
  s_lshl_b32 s34, s36, 6
  s_add_u32 s37, s37, s34
  v_lshlrev_b32 v12, 8, v4
  v_lshl_add_u32 v12, v3, 4, v12
  v_add_u32 v12, s37, v12
  v_add_u32 v12, 77312, v12
  ds_write_b128 v12, v[24:27]
  s_waitcnt lgkmcnt(0)
  v_mov_b32 v12, 68
  v_mov_b32 v13, 1
  s_mov_b64 exec, 1
  ds_add_u32 v12, v13
  s_mov_b64 exec, -1
L_cbar_12:
  ds_read_b32 v13, v12
  s_waitcnt lgkmcnt(0)
  v_readfirstlane_b32 s32, v13
  s_nop 0
  s_cmp_ge_u32 s32, 8
  s_cbranch_scc1 L_cbar_12_d
  s_add_u32 s62, s62, 1
  s_cmp_gt_u32 s62, 0x1000000
  s_cbranch_scc1 L_bail
  s_sleep 0
  s_branch L_cbar_12
L_cbar_12_d:
  s_lshl_b32 s37, s3, 2
  v_add_u32 v12, s37, v3
  v_lshlrev_b32 v13, 8, v12
  v_lshl_add_u32 v13, v4, 4, v13
  v_add_u32 v13, 77312, v13
  ds_read_b128 v[16:19], v13
  s_waitcnt lgkmcnt(0)
  v_max_f32 v20, v16, v17
  v_max3_f32 v20, v20, v18, v19
  s_nop 1
  v_max_f32_dpp v20, v20, v20 row_ror:8 row_mask:0xf bank_mask:0xf
  s_nop 1
  v_max_f32_dpp v20, v20, v20 row_ror:4 row_mask:0xf bank_mask:0xf
  s_nop 1
  v_max_f32_dpp v20, v20, v20 row_ror:2 row_mask:0xf bank_mask:0xf
  s_nop 1
  v_max_f32_dpp v20, v20, v20 row_ror:1 row_mask:0xf bank_mask:0xf
  s_nop 1
  v_mul_f32 v20, s40, v20
  v_fma_f32 v16, v16, s40, -v20
  v_fma_f32 v17, v17, s40, -v20
  v_fma_f32 v18, v18, s40, -v20
  v_fma_f32 v19, v19, s40, -v20
  v_exp_f32 v16, v16
  v_exp_f32 v17, v17
  v_exp_f32 v18, v18
  v_exp_f32 v19, v19
  s_nop 0
  v_add_f32 v21, v16, v17
  v_add_f32 v22, v18, v19
  v_add_f32 v21, v21, v22
  v_cvt_pk_bf16_f32 v22, v16, v17
  v_cvt_pk_bf16_f32 v23, v18, v19
  v_add_f32_dpp v21, v21, v21 row_ror:8 row_mask:0xf bank_mask:0xf
  s_nop 1
  v_add_f32_dpp v21, v21, v21 row_ror:4 row_mask:0xf bank_mask:0xf
  s_nop 1
  v_add_f32_dpp v21, v21, v21 row_ror:2 row_mask:0xf bank_mask:0xf
  s_nop 1
  v_add_f32_dpp v21, v21, v21 row_ror:1 row_mask:0xf bank_mask:0xf
  s_nop 1
  v_mul_u32_u24 v13, 144, v12
  v_lshl_add_u32 v13, v4, 3, v13
  v_add_u32 v13, 10752, v13
  ds_write_b64 v13, v[22:23]
  v_mov_b32 v24, v20
  v_mov_b32 v25, s39
  v_mov_b32 v26, v21
  v_mov_b32 v27, s39
  v_lshlrev_b32 v13, 4, v12
  s_lshl_b32 s34, s2, 9
  s_add_u32 s34, s34, 1310720
  s_mov_b32 exec_lo, 0x00010001
  s_mov_b32 exec_hi, 0x00010001
  buffer_store_dwordx4 v[24:27], v13, s[4:7], s34 offen sc1
  s_mov_b64 exec, -1
  s_waitcnt lgkmcnt(0)
  v_mov_b32 v12, 72
  v_mov_b32 v13, 1
  s_mov_b64 exec, 1
  ds_add_u32 v12, v13
  s_mov_b64 exec, -1
L_cbar_13:
  ds_read_b32 v13, v12
  s_waitcnt lgkmcnt(0)
  v_readfirstlane_b32 s32, v13
  s_nop 0
  s_cmp_ge_u32 s32, 8
  s_cbranch_scc1 L_cbar_13_d
  s_add_u32 s62, s62, 1
  s_cmp_gt_u32 s62, 0x1000000
  s_cbranch_scc1 L_bail
  s_sleep 0
  s_branch L_cbar_13
L_cbar_13_d:
  v_mul_u32_u24 v12, 144, v4
  v_lshl_add_u32 v12, v3, 4, v12
  v_add_u32 v12, 10752, v12
  ds_read_b128 v[16:19], v12 offset:0
  ds_read_b128 v[20:23], v12 offset:64
  ds_read_b128 v[24:27], v12 offset:2304
  ds_read_b128 v[28:31], v12 offset:2368
  v_lshrrev_b32 v13, 2, v4
  v_lshl_add_u32 v13, v3, 3, v13
  v_mul_u32_u24 v13, 1056, v13
  v_and_b32 v12, 3, v4
  v_lshl_add_u32 v13, v12, 3, v13
  s_lshl_b32 s37, s3, 7
  s_add_u32 s37, s37, 85504
  v_add_u32 v13, s37, v13
  ds_read_b64_tr_b16 v[32:33], v13 offset:0
  ds_read_b64_tr_b16 v[34:35], v13 offset:4224
  ds_read_b64_tr_b16 v[36:37], v13 offset:33792
  ds_read_b64_tr_b16 v[38:39], v13 offset:38016
  ds_read_b64_tr_b16 v[40:41], v13 offset:32
  ds_read_b64_tr_b16 v[42:43], v13 offset:4256
  ds_read_b64_tr_b16 v[44:45], v13 offset:33824
  ds_read_b64_tr_b16 v[46:47], v13 offset:38048
  ds_read_b64_tr_b16 v[48:49], v13 offset:64
  ds_read_b64_tr_b16 v[50:51], v13 offset:4288
  ds_read_b64_tr_b16 v[52:53], v13 offset:33856
  ds_read_b64_tr_b16 v[54:55], v13 offset:38080
  ds_read_b64_tr_b16 v[56:57], v13 offset:96
  ds_read_b64_tr_b16 v[58:59], v13 offset:4320
  ds_read_b64_tr_b16 v[60:61], v13 offset:33888
  ds_read_b64_tr_b16 v[62:63], v13 offset:38112
  v_mov_b32 v72, 0
  v_mov_b32 v73, 0
  v_mov_b32 v74, 0
  v_mov_b32 v75, 0
  v_mov_b32 v76, 0
  v_mov_b32 v77, 0
  v_mov_b32 v78, 0
  v_mov_b32 v79, 0
  v_mov_b32 v80, 0
  v_mov_b32 v81, 0
  v_mov_b32 v82, 0
  v_mov_b32 v83, 0
  v_mov_b32 v84, 0
  v_mov_b32 v85, 0
  v_mov_b32 v86, 0
  v_mov_b32 v87, 0
  v_mov_b32 v88, 0
  v_mov_b32 v89, 0
  v_mov_b32 v90, 0
  v_mov_b32 v91, 0
  v_mov_b32 v92, 0
  v_mov_b32 v93, 0
  v_mov_b32 v94, 0
  v_mov_b32 v95, 0
  v_mov_b32 v96, 0
  v_mov_b32 v97, 0
  v_mov_b32 v98, 0
  v_mov_b32 v99, 0
  v_mov_b32 v100, 0
  v_mov_b32 v101, 0
  v_mov_b32 v102, 0
  v_mov_b32 v103, 0
  s_waitcnt lgkmcnt(0)
  v_mfma_f32_16x16x32_bf16 v[72:75], v[32:35], v[16:19], v[72:75]
  v_mfma_f32_16x16x32_bf16 v[72:75], v[36:39], v[20:23], v[72:75]
  v_mfma_f32_16x16x32_bf16 v[76:79], v[32:35], v[24:27], v[76:79]
  v_mfma_f32_16x16x32_bf16 v[76:79], v[36:39], v[28:31], v[76:79]
  v_mfma_f32_16x16x32_bf16 v[80:83], v[40:43], v[16:19], v[80:83]
  v_mfma_f32_16x16x32_bf16 v[80:83], v[44:47], v[20:23], v[80:83]
  v_mfma_f32_16x16x32_bf16 v[84:87], v[40:43], v[24:27], v[84:87]
  v_mfma_f32_16x16x32_bf16 v[84:87], v[44:47], v[28:31], v[84:87]
  v_mfma_f32_16x16x32_bf16 v[88:91], v[48:51], v[16:19], v[88:91]
  v_mfma_f32_16x16x32_bf16 v[88:91], v[52:55], v[20:23], v[88:91]
  v_mfma_f32_16x16x32_bf16 v[92:95], v[48:51], v[24:27], v[92:95]
  v_mfma_f32_16x16x32_bf16 v[92:95], v[52:55], v[28:31], v[92:95]
  v_mfma_f32_16x16x32_bf16 v[96:99], v[56:59], v[16:19], v[96:99]
  v_mfma_f32_16x16x32_bf16 v[96:99], v[60:63], v[20:23], v[96:99]
  v_mfma_f32_16x16x32_bf16 v[100:103], v[56:59], v[24:27], v[100:103]
  v_mfma_f32_16x16x32_bf16 v[100:103], v[60:63], v[28:31], v[100:103]
  s_nop 15
  v_cvt_pk_bf16_f32 v72, v72, v73
  v_cvt_pk_bf16_f32 v74, v74, v75
  v_mov_b32 v73, s39
  v_mov_b32 v75, s39
  v_cvt_pk_bf16_f32 v76, v76, v77
  v_cvt_pk_bf16_f32 v78, v78, v79
  v_mov_b32 v77, s39
  v_mov_b32 v79, s39
  v_cvt_pk_bf16_f32 v80, v80, v81
  v_cvt_pk_bf16_f32 v82, v82, v83
  v_mov_b32 v81, s39
  v_mov_b32 v83, s39
  v_cvt_pk_bf16_f32 v84, v84, v85
  v_cvt_pk_bf16_f32 v86, v86, v87
  v_mov_b32 v85, s39
  v_mov_b32 v87, s39
  v_cvt_pk_bf16_f32 v88, v88, v89
  v_cvt_pk_bf16_f32 v90, v90, v91
  v_mov_b32 v89, s39
  v_mov_b32 v91, s39
  v_cvt_pk_bf16_f32 v92, v92, v93
  v_cvt_pk_bf16_f32 v94, v94, v95
  v_mov_b32 v93, s39
  v_mov_b32 v95, s39
  v_cvt_pk_bf16_f32 v96, v96, v97
  v_cvt_pk_bf16_f32 v98, v98, v99
  v_mov_b32 v97, s39
  v_mov_b32 v99, s39
  v_cvt_pk_bf16_f32 v100, v100, v101
  v_cvt_pk_bf16_f32 v102, v102, v103
  v_mov_b32 v101, s39
  v_mov_b32 v103, s39
  s_lshl_b32 s37, s3, 13
  s_add_u32 s37, s37, 19456
  v_lshlrev_b32 v12, 8, v4
  v_lshl_add_u32 v12, v3, 4, v12
  v_add_u32 v12, s37, v12
  ds_write_b128 v12, v[72:75] offset:0
  ds_write_b128 v12, v[76:79] offset:4096
  ds_write_b128 v12, v[80:83] offset:64
  ds_write_b128 v12, v[84:87] offset:4160
  ds_write_b128 v12, v[88:91] offset:128
  ds_write_b128 v12, v[92:95] offset:4224
  ds_write_b128 v12, v[96:99] offset:192
  ds_write_b128 v12, v[100:103] offset:4288
  v_lshlrev_b32 v13, 4, v2
  v_add_u32 v13, s37, v13
  s_waitcnt lgkmcnt(0)
  ds_read_b128 v[16:19], v13 offset:0
  ds_read_b128 v[20:23], v13 offset:1024
  ds_read_b128 v[24:27], v13 offset:2048
  ds_read_b128 v[28:31], v13 offset:3072
  ds_read_b128 v[32:35], v13 offset:4096
  ds_read_b128 v[36:39], v13 offset:5120
  ds_read_b128 v[40:43], v13 offset:6144
  ds_read_b128 v[44:47], v13 offset:7168
  s_lshl_b32 s34, s2, 16
  s_lshl_b32 s37, s3, 8
  s_add_u32 s34, s34, s37
  s_add_u32 s34, s34, 4194304
  v_lshlrev_b32 v12, 11, v3
  v_lshl_add_u32 v12, v4, 4, v12
  s_waitcnt lgkmcnt(0)
  buffer_store_dwordx4 v[16:19], v12, s[4:7], s34 offen sc1
  s_add_u32 s34, s34, 8192
  buffer_store_dwordx4 v[20:23], v12, s[4:7], s34 offen sc1
  s_add_u32 s34, s34, 8192
  buffer_store_dwordx4 v[24:27], v12, s[4:7], s34 offen sc1
  s_add_u32 s34, s34, 8192
  buffer_store_dwordx4 v[28:31], v12, s[4:7], s34 offen sc1
  s_add_u32 s34, s34, 8192
  buffer_store_dwordx4 v[32:35], v12, s[4:7], s34 offen sc1
  s_add_u32 s34, s34, 8192
  buffer_store_dwordx4 v[36:39], v12, s[4:7], s34 offen sc1
  s_add_u32 s34, s34, 8192
  buffer_store_dwordx4 v[40:43], v12, s[4:7], s34 offen sc1
  s_add_u32 s34, s34, 8192
  buffer_store_dwordx4 v[44:47], v12, s[4:7], s34 offen sc1
  v_mov_b32 v12, 88
  v_mov_b32 v13, 1
  s_mov_b64 exec, 1
  ds_add_u32 v12, v13
  s_mov_b64 exec, -1
  s_waitcnt lgkmcnt(0)
  v_mov_b32 v12, 8
  v_mov_b32 v13, 1
  s_mov_b64 exec, 1
  ds_add_rtn_u32 v13, v12, v13
  s_waitcnt lgkmcnt(0)
  s_mov_b64 exec, -1
  v_readfirstlane_b32 s32, v13
  s_nop 0
  s_cmp_lg_u32 s32, 7
  s_cbranch_scc1 L_C_bdone
  s_lshl_b32 s33, s2, 7
  s_add_u32 s33, s33, 12713984
  v_mov_b32 v12, 0
  v_mov_b32 v13, s39
  s_mov_b64 exec, 1
  buffer_store_dword v13, v12, s[4:7], s33 offen sc1
  s_mov_b64 exec, -1
L_C_bdone:
L_C_noB:
  s_cmp_ge_u32 s2, 144
  s_cselect_b32 s58, 1, 0
  s_mul_i32 s59, s58, 144
  s_sub_u32 s59, s2, s59
  s_and_b32 s60, s59, 15
  s_lshr_b32 s59, s59, 4
  s_cmp_eq_u32 s58, 0
  s_cselect_b32 s54, s86, s96
  s_cselect_b32 s55, s87, s97
  s_mov_b32 s24, s54
  s_and_b32 s25, s55, 0xffff
  s_mov_b32 s26, 4718592
  s_mov_b32 s27, 0x20000
  s_lshl_b32 s33, s60, 8
  s_lshl_b32 s34, s3, 5
  s_add_u32 s33, s33, s34
  v_lshrrev_b32 v12, 3, v2
  v_add_u32 v12, s33, v12
  s_movk_i32 s34, 1152
  v_mul_lo_u32 v12, v12, s34
  v_and_b32 v13, 7, v2
  v_lshl_add_u32 v12, v13, 4, v12
  s_lshl_b32 s34, s59, 7
  buffer_load_dwordx4 v[96:99], v12, s[24:27], s34 offen nt
  s_add_u32 s34, s34, 9216
  buffer_load_dwordx4 v[100:103], v12, s[24:27], s34 offen nt
  s_add_u32 s34, s34, 9216
  buffer_load_dwordx4 v[104:107], v12, s[24:27], s34 offen nt
  s_add_u32 s34, s34, 9216
  buffer_load_dwordx4 v[108:111], v12, s[24:27], s34 offen nt
  s_cmp_lg_u32 s3, 0
  s_cbranch_scc1 L_C_w3
  s_mov_b32 s34, 12713984
  v_lshlrev_b32 v12, 7, v2
  s_add_u32 s51, s34, 8192
L_poll_14:
  buffer_load_dword v16, v12, s[4:7], s34 offen sc1
  buffer_load_dword v17, v12, s[4:7], s51 offen sc1
  s_waitcnt vmcnt(0)
  v_cmp_ne_u32 vcc, s39, v16
  v_cmp_ne_u32 s[36:37], s39, v17
  s_or_b64 vcc, vcc, s[36:37]
  s_cbranch_vccz L_poll_14_d
  s_add_u32 s62, s62, 1
  s_cmp_gt_u32 s62, 0x1000000
  s_cbranch_scc1 L_bail
  s_sleep 2
  s_branch L_poll_14
L_poll_14_d:
  s_mov_b64 exec, -1
  s_waitcnt lgkmcnt(0)
  v_mov_b32 v12, 136
  v_mov_b32 v13, 1
  ds_write_b32 v12, v13
L_C_w3:
  v_mov_b32 v12, 136
L_lw_15:
  ds_read_b32 v13, v12
  s_waitcnt lgkmcnt(0)
  v_readfirstlane_b32 s32, v13
  s_nop 0
  s_cmp_lg_u32 s32, 0
  s_cbranch_scc1 L_lw_15_d
  s_add_u32 s62, s62, 1
  s_cmp_gt_u32 s62, 0x1000000
  s_cbranch_scc1 L_bail
  s_sleep 1
  s_branch L_lw_15
L_lw_15_d:
  s_lshr_b32 s33, s3, 2
  s_and_b32 s35, s3, 3
  s_lshl_b32 s34, s33, 6
  v_add_u32 v12, s34, v2
  v_lshlrev_b32 v12, 5, v12
  v_add_u32 v12, s42, v12
  v_lshlrev_b32 v12, 4, v12
  s_lshl_b32 s34, s35, 4
  v_add_u32 v15, s34, v3
  s_lshl_b32 s34, s33, 6
  v_add_u32 v13, s34, v15
  v_lshlrev_b32 v13, 5, v13
  v_add_u32 v13, s42, v13
  v_lshlrev_b32 v13, 11, v13
  v_lshl_add_u32 v13, v4, 4, v13
  s_lshl_b32 s34, s43, 8
  s_add_u32 s34, s34, 4194304
  s_mov_b32 s35, 1310720
  s_add_u32 s36, s34, 262144
  s_add_u32 s37, s36, 262144
  s_add_u32 s38, s37, 262144
L_tl_16:
  buffer_load_dwordx4 v[40:43], v12, s[4:7], s35 offen sc1
  buffer_load_dwordx4 v[16:19], v13, s[4:7], s34 offen sc1
  buffer_load_dwordx4 v[20:23], v13, s[4:7], s36 offen sc1
  buffer_load_dwordx4 v[24:27], v13, s[4:7], s37 offen sc1
  buffer_load_dwordx4 v[28:31], v13, s[4:7], s38 offen sc1
  s_waitcnt vmcnt(0)
  v_mov_b32 v48, s39
  v_mov_b32 v49, s39
  v_min3_u32 v48, v48, v41, v43
  v_max3_u32 v49, v49, v41, v43
  v_min3_u32 v48, v48, v17, v21
  v_max3_u32 v49, v49, v17, v21
  v_min3_u32 v48, v48, v25, v29
  v_max3_u32 v49, v49, v25, v29
  v_min3_u32 v48, v48, v19, v23
  v_max3_u32 v49, v49, v19, v23
  v_min3_u32 v48, v48, v27, v31
  v_max3_u32 v49, v49, v27, v31
  v_cmp_ne_u32 vcc, v48, v49
  s_cbranch_vccz L_tl_16_d
  s_add_u32 s62, s62, 1
  s_cmp_gt_u32 s62, 0x1000000
  s_cbranch_scc1 L_bail
  s_sleep 2
  s_branch L_tl_16
L_tl_16_d:
  v_mov_b32 v44, v40
  s_nop 1
  v_max_f32_dpp v44, v44, v44 row_ror:8 row_mask:0xf bank_mask:0xf
  s_nop 1
  v_max_f32_dpp v44, v44, v44 row_ror:4 row_mask:0xf bank_mask:0xf
  s_nop 1
  v_max_f32_dpp v44, v44, v44 row_ror:2 row_mask:0xf bank_mask:0xf
  s_nop 1
  v_max_f32_dpp v44, v44, v44 row_ror:1 row_mask:0xf bank_mask:0xf
  s_nop 1
  v_mov_b32 v45, v44
  s_nop 1
  v_permlane16_swap_b32 v44, v45
  s_nop 1
  v_max_f32 v44, v44, v45
  v_mov_b32 v45, v44
  s_nop 1
  v_permlane32_swap_b32 v44, v45
  s_nop 1
  v_max_f32 v44, v44, v45
  v_sub_f32 v40, v40, v44
  v_exp_f32 v40, v40
  s_nop 0
  v_mul_f32 v44, v40, v42
  s_nop 1
  v_add_f32_dpp v44, v44, v44 row_ror:8 row_mask:0xf bank_mask:0xf
  s_nop 1
  v_add_f32_dpp v44, v44, v44 row_ror:4 row_mask:0xf bank_mask:0xf
  s_nop 1
  v_add_f32_dpp v44, v44, v44 row_ror:2 row_mask:0xf bank_mask:0xf
  s_nop 1
  v_add_f32_dpp v44, v44, v44 row_ror:1 row_mask:0xf bank_mask:0xf
  s_nop 1
  v_mov_b32 v45, v44
  s_nop 1
  v_permlane16_swap_b32 v44, v45
  s_nop 1
  v_add_f32 v44, v44, v45
  v_mov_b32 v45, v44
  s_nop 1
  v_permlane32_swap_b32 v44, v45
  s_nop 1
  v_add_f32 v44, v44, v45
  v_rcp_f32 v44, v44
  s_nop 0
  v_mul_f32 v40, v40, v44
  v_add_u32 v45, 0, v15
  v_lshlrev_b32 v45, 2, v45
  ds_bpermute_b32 v48, v45, v40
  v_add_u32 v45, 4, v15
  v_lshlrev_b32 v45, 2, v45
  ds_bpermute_b32 v49, v45, v40
  v_add_u32 v45, 8, v15
  v_lshlrev_b32 v45, 2, v45
  ds_bpermute_b32 v50, v45, v40
  v_add_u32 v45, 12, v15
  v_lshlrev_b32 v45, 2, v45
  ds_bpermute_b32 v51, v45, v40
  s_waitcnt lgkmcnt(0)
  v_mov_b32 v52, 0
  v_mov_b32 v53, 0
  v_mov_b32 v54, 0
  v_mov_b32 v55, 0
  v_lshlrev_b32 v12, 16, v16
  v_and_b32 v13, 0xffff0000, v16
  v_fmac_f32 v52, v48, v12
  v_fmac_f32 v53, v48, v13
  v_lshlrev_b32 v12, 16, v18
  v_and_b32 v13, 0xffff0000, v18
  v_fmac_f32 v54, v48, v12
  v_fmac_f32 v55, v48, v13
  v_lshlrev_b32 v12, 16, v20
  v_and_b32 v13, 0xffff0000, v20
  v_fmac_f32 v52, v49, v12
  v_fmac_f32 v53, v49, v13
  v_lshlrev_b32 v12, 16, v22
  v_and_b32 v13, 0xffff0000, v22
  v_fmac_f32 v54, v49, v12
  v_fmac_f32 v55, v49, v13
  v_lshlrev_b32 v12, 16, v24
  v_and_b32 v13, 0xffff0000, v24
  v_fmac_f32 v52, v50, v12
  v_fmac_f32 v53, v50, v13
  v_lshlrev_b32 v12, 16, v26
  v_and_b32 v13, 0xffff0000, v26
  v_fmac_f32 v54, v50, v12
  v_fmac_f32 v55, v50, v13
  v_lshlrev_b32 v12, 16, v28
  v_and_b32 v13, 0xffff0000, v28
  v_fmac_f32 v52, v51, v12
  v_fmac_f32 v53, v51, v13
  v_lshlrev_b32 v12, 16, v30
  v_and_b32 v13, 0xffff0000, v30
  v_fmac_f32 v54, v51, v12
  v_fmac_f32 v55, v51, v13
  v_mov_b32 v56, v52
  v_mov_b32 v57, v53
  v_mov_b32 v58, v54
  v_mov_b32 v59, v55
  v_permlane16_swap_b32 v52, v56
  v_permlane16_swap_b32 v53, v57
  v_permlane16_swap_b32 v54, v58
  v_permlane16_swap_b32 v55, v59
  v_add_f32 v52, v52, v56
  v_add_f32 v53, v53, v57
  v_add_f32 v54, v54, v58
  v_add_f32 v55, v55, v59
  v_mov_b32 v56, v52
  v_mov_b32 v57, v53
  v_mov_b32 v58, v54
  v_mov_b32 v59, v55
  v_permlane32_swap_b32 v52, v56
  v_permlane32_swap_b32 v53, v57
  v_permlane32_swap_b32 v54, v58
  v_permlane32_swap_b32 v55, v59
  v_add_f32 v52, v52, v56
  v_add_f32 v53, v53, v57
  v_add_f32 v54, v54, v58
  v_add_f32 v55, v55, v59
  s_cmp_ge_u32 s2, 128
  s_cbranch_scc1 L_C_vr
  v_mov_b32 v12, 88
L_ckw_17:
  ds_read_b32 v13, v12
  s_waitcnt lgkmcnt(0)
  v_readfirstlane_b32 s32, v13
  s_nop 0
  s_cmp_ge_u32 s32, 8
  s_cbranch_scc1 L_C_vr
  s_add_u32 s62, s62, 1
  s_cmp_gt_u32 s62, 0x1000000
  s_cbranch_scc1 L_bail
  s_branch L_ckw_17
L_C_vr:
  s_lshl_b32 s34, s3, 8
  s_add_u32 s34, s34, 85504
  v_lshlrev_b32 v12, 4, v4
  v_add_u32 v12, s34, v12
  ds_write_b128 v12, v[52:55]
  s_waitcnt lgkmcnt(0)
  v_mov_b32 v12, 76
  v_mov_b32 v13, 1
  s_mov_b64 exec, 1
  ds_add_u32 v12, v13
  s_mov_b64 exec, -1
L_cbar_18:
  ds_read_b32 v13, v12
  s_waitcnt lgkmcnt(0)
  v_readfirstlane_b32 s32, v13
  s_nop 0
  s_cmp_ge_u32 s32, 8
  s_cbranch_scc1 L_cbar_18_d
  s_add_u32 s62, s62, 1
  s_cmp_gt_u32 s62, 0x1000000
  s_cbranch_scc1 L_bail
  s_sleep 0
  s_branch L_cbar_18
L_cbar_18_d:
  s_lshl_b32 s34, s3, 3
  v_add_u32 v12, s34, v3
  v_lshlrev_b32 v12, 2, v12
  v_add_u32 v12, 85504, v12
  ds_read_b32 v16, v12 offset:0
  ds_read_b32 v17, v12 offset:256
  ds_read_b32 v18, v12 offset:512
  ds_read_b32 v19, v12 offset:768
  ds_read_b32 v20, v12 offset:1024
  ds_read_b32 v21, v12 offset:1280
  ds_read_b32 v22, v12 offset:1536
  ds_read_b32 v23, v12 offset:1792
  ds_read_b32 v24, v12 offset:16
  ds_read_b32 v25, v12 offset:272
  ds_read_b32 v26, v12 offset:528
  ds_read_b32 v27, v12 offset:784
  ds_read_b32 v28, v12 offset:1040
  ds_read_b32 v29, v12 offset:1296
  ds_read_b32 v30, v12 offset:1552
  ds_read_b32 v31, v12 offset:1808
  s_waitcnt lgkmcnt(0)
  v_add_f32 v16, v16, v17
  v_add_f32 v16, v16, v18
  v_add_f32 v16, v16, v19
  v_add_f32 v20, v20, v21
  v_add_f32 v20, v20, v22
  v_add_f32 v20, v20, v23
  v_add_f32 v24, v24, v25
  v_add_f32 v24, v24, v26
  v_add_f32 v24, v24, v27
  v_add_f32 v28, v28, v29
  v_add_f32 v28, v28, v30
  v_add_f32 v28, v28, v31
  v_mov_b32 v32, 0
  v_mov_b32 v33, 0
  v_mov_b32 v34, 0
  v_mov_b32 v35, 0
  v_mov_b32 v36, 0
  v_mov_b32 v37, 0
  v_mov_b32 v38, 0
  v_mov_b32 v39, 0
  v_mov_b32 v40, 0
  v_mov_b32 v41, 0
  v_mov_b32 v42, 0
  v_mov_b32 v43, 0
  v_mov_b32 v44, 0
  v_mov_b32 v45, 0
  v_mov_b32 v46, 0
  v_mov_b32 v47, 0
  v_lshlrev_b32 v12, 16, v64
  v_and_b32 v13, 0xffff0000, v64
  v_fmac_f32 v32, v16, v12
  v_fmac_f32 v33, v16, v13
  v_fmac_f32 v40, v20, v12
  v_fmac_f32 v41, v20, v13
  v_lshlrev_b32 v12, 16, v65
  v_and_b32 v13, 0xffff0000, v65
  v_fmac_f32 v34, v16, v12
  v_fmac_f32 v35, v16, v13
  v_fmac_f32 v42, v20, v12
  v_fmac_f32 v43, v20, v13
  v_lshlrev_b32 v12, 16, v66
  v_and_b32 v13, 0xffff0000, v66
  v_fmac_f32 v36, v16, v12
  v_fmac_f32 v37, v16, v13
  v_fmac_f32 v44, v20, v12
  v_fmac_f32 v45, v20, v13
  v_lshlrev_b32 v12, 16, v67
  v_and_b32 v13, 0xffff0000, v67
  v_fmac_f32 v38, v16, v12
  v_fmac_f32 v39, v16, v13
  v_fmac_f32 v46, v20, v12
  v_fmac_f32 v47, v20, v13
  v_lshlrev_b32 v12, 16, v68
  v_and_b32 v13, 0xffff0000, v68
  v_fmac_f32 v32, v24, v12
  v_fmac_f32 v33, v24, v13
  v_fmac_f32 v40, v28, v12
  v_fmac_f32 v41, v28, v13
  v_lshlrev_b32 v12, 16, v69
  v_and_b32 v13, 0xffff0000, v69
  v_fmac_f32 v34, v24, v12
  v_fmac_f32 v35, v24, v13
  v_fmac_f32 v42, v28, v12
  v_fmac_f32 v43, v28, v13
  v_lshlrev_b32 v12, 16, v70
  v_and_b32 v13, 0xffff0000, v70
  v_fmac_f32 v36, v24, v12
  v_fmac_f32 v37, v24, v13
  v_fmac_f32 v44, v28, v12
  v_fmac_f32 v45, v28, v13
  v_lshlrev_b32 v12, 16, v71
  v_and_b32 v13, 0xffff0000, v71
  v_fmac_f32 v38, v24, v12
  v_fmac_f32 v39, v24, v13
  v_fmac_f32 v46, v28, v12
  v_fmac_f32 v47, v28, v13
  v_mov_b32 v48, v32
  v_mov_b32 v49, v33
  v_mov_b32 v50, v34
  v_mov_b32 v51, v35
  v_mov_b32 v52, v36
  v_mov_b32 v53, v37
  v_mov_b32 v54, v38
  v_mov_b32 v55, v39
  v_mov_b32 v56, v40
  v_mov_b32 v57, v41
  v_mov_b32 v58, v42
  v_mov_b32 v59, v43
  v_mov_b32 v60, v44
  v_mov_b32 v61, v45
  v_mov_b32 v62, v46
  v_mov_b32 v63, v47
  v_permlane16_swap_b32 v32, v48
  v_permlane16_swap_b32 v33, v49
  v_permlane16_swap_b32 v34, v50
  v_permlane16_swap_b32 v35, v51
  v_permlane16_swap_b32 v36, v52
  v_permlane16_swap_b32 v37, v53
  v_permlane16_swap_b32 v38, v54
  v_permlane16_swap_b32 v39, v55
  v_permlane16_swap_b32 v40, v56
  v_permlane16_swap_b32 v41, v57
  v_permlane16_swap_b32 v42, v58
  v_permlane16_swap_b32 v43, v59
  v_permlane16_swap_b32 v44, v60
  v_permlane16_swap_b32 v45, v61
  v_permlane16_swap_b32 v46, v62
  v_permlane16_swap_b32 v47, v63
  v_add_f32 v32, v32, v48
  v_add_f32 v33, v33, v49
  v_add_f32 v34, v34, v50
  v_add_f32 v35, v35, v51
  v_add_f32 v36, v36, v52
  v_add_f32 v37, v37, v53
  v_add_f32 v38, v38, v54
  v_add_f32 v39, v39, v55
  v_add_f32 v40, v40, v56
  v_add_f32 v41, v41, v57
  v_add_f32 v42, v42, v58
  v_add_f32 v43, v43, v59
  v_add_f32 v44, v44, v60
  v_add_f32 v45, v45, v61
  v_add_f32 v46, v46, v62
  v_add_f32 v47, v47, v63
  v_mov_b32 v48, v32
  v_mov_b32 v49, v33
  v_mov_b32 v50, v34
  v_mov_b32 v51, v35
  v_mov_b32 v52, v36
  v_mov_b32 v53, v37
  v_mov_b32 v54, v38
  v_mov_b32 v55, v39
  v_mov_b32 v56, v40
  v_mov_b32 v57, v41
  v_mov_b32 v58, v42
  v_mov_b32 v59, v43
  v_mov_b32 v60, v44
  v_mov_b32 v61, v45
  v_mov_b32 v62, v46
  v_mov_b32 v63, v47
  v_permlane32_swap_b32 v32, v48
  v_permlane32_swap_b32 v33, v49
  v_permlane32_swap_b32 v34, v50
  v_permlane32_swap_b32 v35, v51
  v_permlane32_swap_b32 v36, v52
  v_permlane32_swap_b32 v37, v53
  v_permlane32_swap_b32 v38, v54
  v_permlane32_swap_b32 v39, v55
  v_permlane32_swap_b32 v40, v56
  v_permlane32_swap_b32 v41, v57
  v_permlane32_swap_b32 v42, v58
  v_permlane32_swap_b32 v43, v59
  v_permlane32_swap_b32 v44, v60
  v_permlane32_swap_b32 v45, v61
  v_permlane32_swap_b32 v46, v62
  v_permlane32_swap_b32 v47, v63
  v_add_f32 v32, v32, v48
  v_add_f32 v33, v33, v49
  v_add_f32 v34, v34, v50
  v_add_f32 v35, v35, v51
  v_add_f32 v36, v36, v52
  v_add_f32 v37, v37, v53
  v_add_f32 v38, v38, v54
  v_add_f32 v39, v39, v55
  v_add_f32 v40, v40, v56
  v_add_f32 v41, v41, v57
  v_add_f32 v42, v42, v58
  v_add_f32 v43, v43, v59
  v_add_f32 v44, v44, v60
  v_add_f32 v45, v45, v61
  v_add_f32 v46, v46, v62
  v_add_f32 v47, v47, v63
  s_lshl_b32 s34, s3, 10
  s_add_u32 s34, s34, 89600
  v_lshlrev_b32 v12, 5, v4
  v_add_u32 v12, s34, v12
  s_mov_b64 exec, 0xffff
  ds_write_b128 v12, v[32:35]
  ds_write_b128 v12, v[36:39] offset:16
  ds_write_b128 v12, v[40:43] offset:512
  ds_write_b128 v12, v[44:47] offset:528
  s_mov_b64 exec, -1
  s_waitcnt lgkmcnt(0)
  v_mov_b32 v12, 12
  v_mov_b32 v13, 1
  s_mov_b64 exec, 1
  ds_add_rtn_u32 v13, v12, v13
  s_waitcnt lgkmcnt(0)
  s_mov_b64 exec, -1
  v_readfirstlane_b32 s32, v13
  s_nop 0
  s_cmp_lg_u32 s32, 7
  s_cbranch_scc1 L_C_vdone
  v_lshlrev_b32 v12, 4, v2
  v_add_u32 v13, 89600, v12
  ds_read_b128 v[16:19], v13 offset:0
  ds_read_b128 v[20:23], v13 offset:1024
  ds_read_b128 v[24:27], v13 offset:2048
  ds_read_b128 v[28:31], v13 offset:3072
  ds_read_b128 v[32:35], v13 offset:4096
  ds_read_b128 v[36:39], v13 offset:5120
  ds_read_b128 v[40:43], v13 offset:6144
  ds_read_b128 v[44:47], v13 offset:7168
  s_waitcnt lgkmcnt(0)
  v_add_f32 v16, v16, v20
  v_add_f32 v17, v17, v21
  v_add_f32 v18, v18, v22
  v_add_f32 v19, v19, v23
  v_add_f32 v16, v16, v24
  v_add_f32 v17, v17, v25
  v_add_f32 v18, v18, v26
  v_add_f32 v19, v19, v27
  v_add_f32 v16, v16, v28
  v_add_f32 v17, v17, v29
  v_add_f32 v18, v18, v30
  v_add_f32 v19, v19, v31
  v_add_f32 v16, v16, v32
  v_add_f32 v17, v17, v33
  v_add_f32 v18, v18, v34
  v_add_f32 v19, v19, v35
  v_add_f32 v16, v16, v36
  v_add_f32 v17, v17, v37
  v_add_f32 v18, v18, v38
  v_add_f32 v19, v19, v39
  v_add_f32 v16, v16, v40
  v_add_f32 v17, v17, v41
  v_add_f32 v18, v18, v42
  v_add_f32 v19, v19, v43
  v_add_f32 v16, v16, v44
  v_add_f32 v17, v17, v45
  v_add_f32 v18, v18, v46
  v_add_f32 v19, v19, v47
  s_lshl_b32 s34, s2, 11
  s_add_u32 s34, s34, 1376256
  v_lshlrev_b32 v12, 5, v2
  v_mov_b32 v48, v16
  v_mov_b32 v49, s39
  v_mov_b32 v50, v17
  v_mov_b32 v51, s39
  v_mov_b32 v52, v18
  v_mov_b32 v53, s39
  v_mov_b32 v54, v19
  v_mov_b32 v55, s39
  buffer_store_dwordx4 v[48:51], v12, s[4:7], s34 offen sc1
  buffer_store_dwordx4 v[52:55], v12, s[4:7], s34 offen offset:16 sc1
  s_lshl_b32 s33, s2, 7
  s_add_u32 s33, s33, 12779520
  v_mov_b32 v12, 0
  v_mov_b32 v13, s39
  s_mov_b64 exec, 1
  buffer_store_dword v13, v12, s[4:7], s33 offen sc1
  s_mov_b64 exec, -1
L_C_vdone:
  s_cmp_ge_u32 s2, 144
  s_cselect_b32 s58, 1, 0
  s_mul_i32 s59, s58, 144
  s_sub_u32 s59, s2, s59
  s_and_b32 s60, s59, 15
  s_lshr_b32 s59, s59, 4
  s_cmp_lg_u32 s3, 0
  s_cbranch_scc1 L_ow_22
  s_cmp_eq_u32 s58, 0
  s_cbranch_scc0 L_op_24
  s_add_u32 s34, s60, 0
  s_lshl_b32 s34, s34, 10
  s_add_u32 s34, s34, 12845056
  v_lshlrev_b32 v12, 7, v2
  s_mov_b64 exec, 0xff
L_poll_25:
  buffer_load_dword v16, v12, s[4:7], s34 offen sc1
  s_waitcnt vmcnt(0)
  v_cmp_ne_u32 vcc, s39, v16
  s_cbranch_vccz L_poll_25_d
  s_add_u32 s62, s62, 1
  s_cmp_gt_u32 s62, 0x1000000
  s_cbranch_scc1 L_bail
  s_sleep 2
  s_branch L_poll_25
L_poll_25_d:
  s_mov_b64 exec, -1
  s_add_u32 s34, s60, 16
  s_lshl_b32 s34, s34, 10
  s_add_u32 s34, s34, 12845056
  v_lshlrev_b32 v12, 7, v2
  s_mov_b64 exec, 0xff
L_poll_26:
  buffer_load_dword v16, v12, s[4:7], s34 offen sc1
  s_waitcnt vmcnt(0)
  v_cmp_ne_u32 vcc, s39, v16
  s_cbranch_vccz L_poll_26_d
  s_add_u32 s62, s62, 1
  s_cmp_gt_u32 s62, 0x1000000
  s_cbranch_scc1 L_bail
  s_sleep 2
  s_branch L_poll_26
L_poll_26_d:
  s_mov_b64 exec, -1
  s_branch L_ow2_23
L_op_24:
  s_lshl_b32 s34, s60, 11
  s_add_u32 s34, s34, 12779520
  v_lshlrev_b32 v12, 7, v2
  s_mov_b64 exec, 0xffff
L_poll_27:
  buffer_load_dword v16, v12, s[4:7], s34 offen sc1
  s_waitcnt vmcnt(0)
  v_cmp_ne_u32 vcc, s39, v16
  s_cbranch_vccz L_poll_27_d
  s_add_u32 s62, s62, 1
  s_cmp_gt_u32 s62, 0x1000000
  s_cbranch_scc1 L_bail
  s_sleep 2
  s_branch L_poll_27
L_poll_27_d:
  s_mov_b64 exec, -1
L_ow2_23:
  s_waitcnt lgkmcnt(0)
  v_mov_b32 v12, 140
  v_mov_b32 v13, 1
  ds_write_b32 v12, v13
L_ow_22:
  v_mov_b32 v12, 140
L_lw_28:
  ds_read_b32 v13, v12
  s_waitcnt lgkmcnt(0)
  v_readfirstlane_b32 s32, v13
  s_nop 0
  s_cmp_lg_u32 s32, 0
  s_cbranch_scc1 L_lw_28_d
  s_add_u32 s62, s62, 1
  s_cmp_gt_u32 s62, 0x1000000
  s_cbranch_scc1 L_bail
  s_sleep 1
  s_branch L_lw_28
L_lw_28_d:
  s_cmp_eq_u32 s58, 0
  s_cbranch_scc0 L_ob_19
  s_lshr_b32 s33, s3, 2
  s_and_b32 s35, s3, 3
  s_lshl_b32 s34, s33, 4
  s_add_u32 s34, s34, s60
  s_lshl_b32 s36, s34, 14
  s_lshl_b32 s37, s35, 9
  s_add_u32 s36, s36, s37
  s_add_u32 s36, s36, 720896
  v_lshlrev_b32 v12, 3, v2
  s_add_u32 s37, s36, 4096
  s_add_u32 s38, s36, 8192
  s_add_u32 s32, s36, 12288
  s_lshl_b32 s34, s34, 8
  s_lshr_b32 s33, s35, 1
  s_lshl_b32 s33, s33, 4
  s_add_u32 s34, s34, s33
  s_add_u32 s34, s34, 1245184
  v_mov_b32 v13, 0
L_tl_29:
  buffer_load_dwordx2 v[16:17], v12, s[4:7], s36 offen offset:0 sc1
  buffer_load_dwordx2 v[18:19], v12, s[4:7], s36 offen offset:2048 sc1
  buffer_load_dwordx2 v[20:21], v12, s[4:7], s37 offen offset:0 sc1
  buffer_load_dwordx2 v[22:23], v12, s[4:7], s37 offen offset:2048 sc1
  buffer_load_dwordx2 v[24:25], v12, s[4:7], s38 offen offset:0 sc1
  buffer_load_dwordx2 v[26:27], v12, s[4:7], s38 offen offset:2048 sc1
  buffer_load_dwordx2 v[28:29], v12, s[4:7], s32 offen offset:0 sc1
  buffer_load_dwordx2 v[30:31], v12, s[4:7], s32 offen offset:2048 sc1
  buffer_load_dwordx4 v[32:35], v13, s[4:7], s34 offen offset:0 sc1
  buffer_load_dwordx4 v[36:39], v13, s[4:7], s34 offen offset:32 sc1
  buffer_load_dwordx4 v[40:43], v13, s[4:7], s34 offen offset:64 sc1
  buffer_load_dwordx4 v[44:47], v13, s[4:7], s34 offen offset:96 sc1
  buffer_load_dwordx4 v[48:51], v13, s[4:7], s34 offen offset:128 sc1
  buffer_load_dwordx4 v[52:55], v13, s[4:7], s34 offen offset:160 sc1
  buffer_load_dwordx4 v[56:59], v13, s[4:7], s34 offen offset:192 sc1
  buffer_load_dwordx4 v[60:63], v13, s[4:7], s34 offen offset:224 sc1
  s_waitcnt vmcnt(0)
  v_mov_b32 v14, s39
  v_mov_b32 v15, s39
  v_min3_u32 v14, v14, v17, v19
  v_max3_u32 v15, v15, v17, v19
  v_min3_u32 v14, v14, v21, v23
  v_max3_u32 v15, v15, v21, v23
  v_min3_u32 v14, v14, v25, v27
  v_max3_u32 v15, v15, v25, v27
  v_min3_u32 v14, v14, v29, v31
  v_max3_u32 v15, v15, v29, v31
  v_min3_u32 v14, v14, v33, v37
  v_max3_u32 v15, v15, v33, v37
  v_min3_u32 v14, v14, v41, v45
  v_max3_u32 v15, v15, v41, v45
  v_min3_u32 v14, v14, v49, v53
  v_max3_u32 v15, v15, v49, v53
  v_min3_u32 v14, v14, v57, v61
  v_max3_u32 v15, v15, v57, v61
  v_min3_u32 v14, v14, v35, v39
  v_max3_u32 v15, v15, v35, v39
  v_min3_u32 v14, v14, v43, v47
  v_max3_u32 v15, v15, v43, v47
  v_min3_u32 v14, v14, v51, v55
  v_max3_u32 v15, v15, v51, v55
  v_min3_u32 v14, v14, v59, v63
  v_max3_u32 v15, v15, v59, v63
  v_cmp_ne_u32 vcc, v14, v15
  s_cbranch_vccz L_tl_29_d
  s_add_u32 s62, s62, 1
  s_cmp_gt_u32 s62, 0x1000000
  s_cbranch_scc1 L_bail
  s_sleep 2
  s_branch L_tl_29
L_tl_29_d:
  v_max_f32 v13, v32, v36
  v_max_f32 v13, v13, v40
  v_max_f32 v13, v13, v44
  v_max_f32 v13, v13, v48
  v_max_f32 v13, v13, v52
  v_max_f32 v13, v13, v56
  v_max_f32 v13, v13, v60
  v_sub_f32 v32, v32, v13
  v_sub_f32 v36, v36, v13
  v_sub_f32 v40, v40, v13
  v_sub_f32 v44, v44, v13
  v_sub_f32 v48, v48, v13
  v_sub_f32 v52, v52, v13
  v_sub_f32 v56, v56, v13
  v_sub_f32 v60, v60, v13
  v_exp_f32 v32, v32
  v_exp_f32 v36, v36
  v_exp_f32 v40, v40
  v_exp_f32 v44, v44
  v_exp_f32 v48, v48
  v_exp_f32 v52, v52
  v_exp_f32 v56, v56
  v_exp_f32 v60, v60
  v_mov_b32 v14, 0
  v_mov_b32 v15, 0
  v_fmac_f32 v14, v32, v34
  v_fmac_f32 v15, v32, v16
  v_fmac_f32 v14, v36, v38
  v_fmac_f32 v15, v36, v18
  v_fmac_f32 v14, v40, v42
  v_fmac_f32 v15, v40, v20
  v_fmac_f32 v14, v44, v46
  v_fmac_f32 v15, v44, v22
  v_fmac_f32 v14, v48, v50
  v_fmac_f32 v15, v48, v24
  v_fmac_f32 v14, v52, v54
  v_fmac_f32 v15, v52, v26
  v_fmac_f32 v14, v56, v58
  v_fmac_f32 v15, v56, v28
  v_fmac_f32 v14, v60, v62
  v_fmac_f32 v15, v60, v30
  v_rcp_f32 v14, v14
  s_nop 0
  v_mul_f32 v15, v15, v14
  s_branch L_oj_20
L_ob_19:
  s_lshr_b32 s33, s3, 2
  s_and_b32 s35, s3, 3
  s_lshr_b32 s37, s35, 1
  s_lshl_b32 s34, s60, 1
  s_add_u32 s34, s34, s37
  s_lshl_b32 s36, s34, 14
  s_lshl_b32 s37, s33, 10
  s_add_u32 s36, s36, s37
  s_and_b32 s37, s35, 1
  s_lshl_b32 s37, s37, 9
  s_add_u32 s36, s36, s37
  s_add_u32 s36, s36, 1376256
  v_lshlrev_b32 v12, 3, v2
  s_add_u32 s37, s36, 4096
  s_add_u32 s38, s36, 8192
  s_add_u32 s32, s36, 12288
L_tl_30:
  buffer_load_dwordx2 v[16:17], v12, s[4:7], s36 offen offset:0 sc1
  buffer_load_dwordx2 v[18:19], v12, s[4:7], s36 offen offset:2048 sc1
  buffer_load_dwordx2 v[20:21], v12, s[4:7], s37 offen offset:0 sc1
  buffer_load_dwordx2 v[22:23], v12, s[4:7], s37 offen offset:2048 sc1
  buffer_load_dwordx2 v[24:25], v12, s[4:7], s38 offen offset:0 sc1
  buffer_load_dwordx2 v[26:27], v12, s[4:7], s38 offen offset:2048 sc1
  buffer_load_dwordx2 v[28:29], v12, s[4:7], s32 offen offset:0 sc1
  buffer_load_dwordx2 v[30:31], v12, s[4:7], s32 offen offset:2048 sc1
  s_waitcnt vmcnt(0)
  v_mov_b32 v14, s39
  v_mov_b32 v15, s39
  v_min3_u32 v14, v14, v17, v19
  v_max3_u32 v15, v15, v17, v19
  v_min3_u32 v14, v14, v21, v23
  v_max3_u32 v15, v15, v21, v23
  v_min3_u32 v14, v14, v25, v27
  v_max3_u32 v15, v15, v25, v27
  v_min3_u32 v14, v14, v29, v31
  v_max3_u32 v15, v15, v29, v31
  v_cmp_ne_u32 vcc, v14, v15
  s_cbranch_vccz L_tl_30_d
  s_add_u32 s62, s62, 1
  s_cmp_gt_u32 s62, 0x1000000
  s_cbranch_scc1 L_bail
  s_sleep 2
  s_branch L_tl_30
L_tl_30_d:
  v_mov_b32 v15, v16
  v_add_f32 v15, v15, v18
  v_add_f32 v15, v15, v20
  v_add_f32 v15, v15, v22
  v_add_f32 v15, v15, v24
  v_add_f32 v15, v15, v26
  v_add_f32 v15, v15, v28
  v_add_f32 v15, v15, v30
L_oj_20:
  v_cvt_pk_bf16_f32 v15, v15, v15
  v_lshlrev_b32 v15, 16, v15
  s_lshl_b32 s34, s3, 8
  s_add_u32 s34, s34, 15360
  v_lshlrev_b32 v12, 2, v2
  v_add_u32 v12, s34, v12
  ds_write_b32 v12, v15
  s_waitcnt lgkmcnt(0)
  v_mov_b32 v12, 80
  v_mov_b32 v13, 1
  s_mov_b64 exec, 1
  ds_add_u32 v12, v13
  s_mov_b64 exec, -1
L_cbar_31:
  ds_read_b32 v13, v12
  s_waitcnt lgkmcnt(0)
  v_readfirstlane_b32 s32, v13
  s_nop 0
  s_cmp_ge_u32 s32, 8
  s_cbranch_scc1 L_cbar_31_d
  s_add_u32 s62, s62, 1
  s_cmp_gt_u32 s62, 0x1000000
  s_cbranch_scc1 L_bail
  s_sleep 0
  s_branch L_cbar_31
L_cbar_31_d:
  s_lshl_b32 s34, s3, 5
  v_lshrrev_b32 v12, 3, v2
  v_add_u32 v12, s34, v12
  v_lshlrev_b32 v12, 2, v12
  v_add_u32 v12, 15360, v12
  ds_read_b32 v16, v12 offset:0
  ds_read_b32 v17, v12 offset:1024
  ds_read_b32 v18, v12 offset:32
  ds_read_b32 v19, v12 offset:1056
  ds_read_b32 v20, v12 offset:64
  ds_read_b32 v21, v12 offset:1088
  ds_read_b32 v22, v12 offset:96
  ds_read_b32 v23, v12 offset:1120
  v_mov_b32 v32, 0
  v_mov_b32 v33, 0
  v_mov_b32 v34, 0
  v_mov_b32 v35, 0
  v_mov_b32 v36, 0
  v_mov_b32 v37, 0
  v_mov_b32 v38, 0
  v_mov_b32 v39, 0
  v_mov_b32 v40, 0
  v_mov_b32 v41, 0
  v_mov_b32 v42, 0
  v_mov_b32 v43, 0
  v_mov_b32 v44, 0
  v_mov_b32 v45, 0
  v_mov_b32 v46, 0
  v_mov_b32 v47, 0
  s_waitcnt vmcnt(0) lgkmcnt(0)
  v_lshlrev_b32 v12, 16, v96
  v_and_b32 v13, 0xffff0000, v96
  v_fmac_f32 v32, v16, v12
  v_fmac_f32 v33, v16, v13
  v_fmac_f32 v40, v17, v12
  v_fmac_f32 v41, v17, v13
  v_lshlrev_b32 v12, 16, v97
  v_and_b32 v13, 0xffff0000, v97
  v_fmac_f32 v34, v16, v12
  v_fmac_f32 v35, v16, v13
  v_fmac_f32 v42, v17, v12
  v_fmac_f32 v43, v17, v13
  v_lshlrev_b32 v12, 16, v98
  v_and_b32 v13, 0xffff0000, v98
  v_fmac_f32 v36, v16, v12
  v_fmac_f32 v37, v16, v13
  v_fmac_f32 v44, v17, v12
  v_fmac_f32 v45, v17, v13
  v_lshlrev_b32 v12, 16, v99
  v_and_b32 v13, 0xffff0000, v99
  v_fmac_f32 v38, v16, v12
  v_fmac_f32 v39, v16, v13
  v_fmac_f32 v46, v17, v12
  v_fmac_f32 v47, v17, v13
  v_lshlrev_b32 v12, 16, v100
  v_and_b32 v13, 0xffff0000, v100
  v_fmac_f32 v32, v18, v12
  v_fmac_f32 v33, v18, v13
  v_fmac_f32 v40, v19, v12
  v_fmac_f32 v41, v19, v13
  v_lshlrev_b32 v12, 16, v101
  v_and_b32 v13, 0xffff0000, v101
  v_fmac_f32 v34, v18, v12
  v_fmac_f32 v35, v18, v13
  v_fmac_f32 v42, v19, v12
  v_fmac_f32 v43, v19, v13
  v_lshlrev_b32 v12, 16, v102
  v_and_b32 v13, 0xffff0000, v102
  v_fmac_f32 v36, v18, v12
  v_fmac_f32 v37, v18, v13
  v_fmac_f32 v44, v19, v12
  v_fmac_f32 v45, v19, v13
  v_lshlrev_b32 v12, 16, v103
  v_and_b32 v13, 0xffff0000, v103
  v_fmac_f32 v38, v18, v12
  v_fmac_f32 v39, v18, v13
  v_fmac_f32 v46, v19, v12
  v_fmac_f32 v47, v19, v13
  v_lshlrev_b32 v12, 16, v104
  v_and_b32 v13, 0xffff0000, v104
  v_fmac_f32 v32, v20, v12
  v_fmac_f32 v33, v20, v13
  v_fmac_f32 v40, v21, v12
  v_fmac_f32 v41, v21, v13
  v_lshlrev_b32 v12, 16, v105
  v_and_b32 v13, 0xffff0000, v105
  v_fmac_f32 v34, v20, v12
  v_fmac_f32 v35, v20, v13
  v_fmac_f32 v42, v21, v12
  v_fmac_f32 v43, v21, v13
  v_lshlrev_b32 v12, 16, v106
  v_and_b32 v13, 0xffff0000, v106
  v_fmac_f32 v36, v20, v12
  v_fmac_f32 v37, v20, v13
  v_fmac_f32 v44, v21, v12
  v_fmac_f32 v45, v21, v13
  v_lshlrev_b32 v12, 16, v107
  v_and_b32 v13, 0xffff0000, v107
  v_fmac_f32 v38, v20, v12
  v_fmac_f32 v39, v20, v13
  v_fmac_f32 v46, v21, v12
  v_fmac_f32 v47, v21, v13
  v_lshlrev_b32 v12, 16, v108
  v_and_b32 v13, 0xffff0000, v108
  v_fmac_f32 v32, v22, v12
  v_fmac_f32 v33, v22, v13
  v_fmac_f32 v40, v23, v12
  v_fmac_f32 v41, v23, v13
  v_lshlrev_b32 v12, 16, v109
  v_and_b32 v13, 0xffff0000, v109
  v_fmac_f32 v34, v22, v12
  v_fmac_f32 v35, v22, v13
  v_fmac_f32 v42, v23, v12
  v_fmac_f32 v43, v23, v13
  v_lshlrev_b32 v12, 16, v110
  v_and_b32 v13, 0xffff0000, v110
  v_fmac_f32 v36, v22, v12
  v_fmac_f32 v37, v22, v13
  v_fmac_f32 v44, v23, v12
  v_fmac_f32 v45, v23, v13
  v_lshlrev_b32 v12, 16, v111
  v_and_b32 v13, 0xffff0000, v111
  v_fmac_f32 v38, v22, v12
  v_fmac_f32 v39, v22, v13
  v_fmac_f32 v46, v23, v12
  v_fmac_f32 v47, v23, v13
  v_add_f32_dpp v32, v32, v32 row_ror:8 row_mask:0xf bank_mask:0xf
  v_add_f32_dpp v33, v33, v33 row_ror:8 row_mask:0xf bank_mask:0xf
  v_add_f32_dpp v34, v34, v34 row_ror:8 row_mask:0xf bank_mask:0xf
  v_add_f32_dpp v35, v35, v35 row_ror:8 row_mask:0xf bank_mask:0xf
  v_add_f32_dpp v36, v36, v36 row_ror:8 row_mask:0xf bank_mask:0xf
  v_add_f32_dpp v37, v37, v37 row_ror:8 row_mask:0xf bank_mask:0xf
  v_add_f32_dpp v38, v38, v38 row_ror:8 row_mask:0xf bank_mask:0xf
  v_add_f32_dpp v39, v39, v39 row_ror:8 row_mask:0xf bank_mask:0xf
  v_add_f32_dpp v40, v40, v40 row_ror:8 row_mask:0xf bank_mask:0xf
  v_add_f32_dpp v41, v41, v41 row_ror:8 row_mask:0xf bank_mask:0xf
  v_add_f32_dpp v42, v42, v42 row_ror:8 row_mask:0xf bank_mask:0xf
  v_add_f32_dpp v43, v43, v43 row_ror:8 row_mask:0xf bank_mask:0xf
  v_add_f32_dpp v44, v44, v44 row_ror:8 row_mask:0xf bank_mask:0xf
  v_add_f32_dpp v45, v45, v45 row_ror:8 row_mask:0xf bank_mask:0xf
  v_add_f32_dpp v46, v46, v46 row_ror:8 row_mask:0xf bank_mask:0xf
  v_add_f32_dpp v47, v47, v47 row_ror:8 row_mask:0xf bank_mask:0xf
  v_mov_b32 v48, v32
  v_mov_b32 v49, v33
  v_mov_b32 v50, v34
  v_mov_b32 v51, v35
  v_mov_b32 v52, v36
  v_mov_b32 v53, v37
  v_mov_b32 v54, v38
  v_mov_b32 v55, v39
  v_mov_b32 v56, v40
  v_mov_b32 v57, v41
  v_mov_b32 v58, v42
  v_mov_b32 v59, v43
  v_mov_b32 v60, v44
  v_mov_b32 v61, v45
  v_mov_b32 v62, v46
  v_mov_b32 v63, v47
  v_permlane16_swap_b32 v32, v48
  v_permlane16_swap_b32 v33, v49
  v_permlane16_swap_b32 v34, v50
  v_permlane16_swap_b32 v35, v51
  v_permlane16_swap_b32 v36, v52
  v_permlane16_swap_b32 v37, v53
  v_permlane16_swap_b32 v38, v54
  v_permlane16_swap_b32 v39, v55
  v_permlane16_swap_b32 v40, v56
  v_permlane16_swap_b32 v41, v57
  v_permlane16_swap_b32 v42, v58
  v_permlane16_swap_b32 v43, v59
  v_permlane16_swap_b32 v44, v60
  v_permlane16_swap_b32 v45, v61
  v_permlane16_swap_b32 v46, v62
  v_permlane16_swap_b32 v47, v63
  v_add_f32 v32, v32, v48
  v_add_f32 v33, v33, v49
  v_add_f32 v34, v34, v50
  v_add_f32 v35, v35, v51
  v_add_f32 v36, v36, v52
  v_add_f32 v37, v37, v53
  v_add_f32 v38, v38, v54
  v_add_f32 v39, v39, v55
  v_add_f32 v40, v40, v56
  v_add_f32 v41, v41, v57
  v_add_f32 v42, v42, v58
  v_add_f32 v43, v43, v59
  v_add_f32 v44, v44, v60
  v_add_f32 v45, v45, v61
  v_add_f32 v46, v46, v62
  v_add_f32 v47, v47, v63
  v_mov_b32 v48, v32
  v_mov_b32 v49, v33
  v_mov_b32 v50, v34
  v_mov_b32 v51, v35
  v_mov_b32 v52, v36
  v_mov_b32 v53, v37
  v_mov_b32 v54, v38
  v_mov_b32 v55, v39
  v_mov_b32 v56, v40
  v_mov_b32 v57, v41
  v_mov_b32 v58, v42
  v_mov_b32 v59, v43
  v_mov_b32 v60, v44
  v_mov_b32 v61, v45
  v_mov_b32 v62, v46
  v_mov_b32 v63, v47
  v_permlane32_swap_b32 v32, v48
  v_permlane32_swap_b32 v33, v49
  v_permlane32_swap_b32 v34, v50
  v_permlane32_swap_b32 v35, v51
  v_permlane32_swap_b32 v36, v52
  v_permlane32_swap_b32 v37, v53
  v_permlane32_swap_b32 v38, v54
  v_permlane32_swap_b32 v39, v55
  v_permlane32_swap_b32 v40, v56
  v_permlane32_swap_b32 v41, v57
  v_permlane32_swap_b32 v42, v58
  v_permlane32_swap_b32 v43, v59
  v_permlane32_swap_b32 v44, v60
  v_permlane32_swap_b32 v45, v61
  v_permlane32_swap_b32 v46, v62
  v_permlane32_swap_b32 v47, v63
  v_add_f32 v32, v32, v48
  v_add_f32 v33, v33, v49
  v_add_f32 v34, v34, v50
  v_add_f32 v35, v35, v51
  v_add_f32 v36, v36, v52
  v_add_f32 v37, v37, v53
  v_add_f32 v38, v38, v54
  v_add_f32 v39, v39, v55
  v_add_f32 v40, v40, v56
  v_add_f32 v41, v41, v57
  v_add_f32 v42, v42, v58
  v_add_f32 v43, v43, v59
  v_add_f32 v44, v44, v60
  v_add_f32 v45, v45, v61
  v_add_f32 v46, v46, v62
  v_add_f32 v47, v47, v63
  s_lshl_b32 s34, s3, 9
  s_add_u32 s34, s34, 101888
  v_lshlrev_b32 v12, 5, v2
  v_add_u32 v12, s34, v12
  s_mov_b64 exec, 0xff
  ds_write_b128 v12, v[32:35]
  ds_write_b128 v12, v[36:39] offset:16
  ds_write_b128 v12, v[40:43] offset:256
  ds_write_b128 v12, v[44:47] offset:272
  s_mov_b64 exec, -1
  s_waitcnt lgkmcnt(0)
  v_mov_b32 v12, 20
  v_mov_b32 v13, 1
  s_mov_b64 exec, 1
  ds_add_rtn_u32 v13, v12, v13
  s_waitcnt lgkmcnt(0)
  s_mov_b64 exec, -1
  v_readfirstlane_b32 s32, v13
  s_nop 0
  s_cmp_lg_u32 s32, 7
  s_cbranch_scc1 L_od_21
  v_lshlrev_b32 v12, 3, v2
  v_add_u32 v13, 101888, v12
  ds_read_b64 v[16:17], v13 offset:0
  ds_read_b64 v[18:19], v13 offset:512
  ds_read_b64 v[20:21], v13 offset:1024
  ds_read_b64 v[22:23], v13 offset:1536
  ds_read_b64 v[24:25], v13 offset:2048
  ds_read_b64 v[26:27], v13 offset:2560
  ds_read_b64 v[28:29], v13 offset:3072
  ds_read_b64 v[30:31], v13 offset:3584
  s_waitcnt lgkmcnt(0)
  v_add_f32 v16, v16, v18
  v_add_f32 v17, v17, v19
  v_add_f32 v16, v16, v20
  v_add_f32 v17, v17, v21
  v_add_f32 v16, v16, v22
  v_add_f32 v17, v17, v23
  v_add_f32 v16, v16, v24
  v_add_f32 v17, v17, v25
  v_add_f32 v16, v16, v26
  v_add_f32 v17, v17, v27
  v_add_f32 v16, v16, v28
  v_add_f32 v17, v17, v29
  v_add_f32 v16, v16, v30
  v_add_f32 v17, v17, v31
  v_mov_b32 v18, v17
  v_mov_b32 v17, s39
  v_mov_b32 v19, s39
  s_lshl_b32 s34, s2, 10
  s_add_u32 s34, s34, 1900544
  v_lshlrev_b32 v12, 4, v2
  buffer_store_dwordx4 v[16:19], v12, s[4:7], s34 offen sc1
  s_lshl_b32 s33, s2, 7
  s_add_u32 s33, s33, 12910592
  v_mov_b32 v12, 0
  v_mov_b32 v13, s39
  s_mov_b64 exec, 1
  buffer_store_dword v13, v12, s[4:7], s33 offen sc1
  s_mov_b64 exec, -1
L_od_21:
  s_sub_u32 s61, s2, 240
  s_cmp_lt_u32 s61, 9
  s_cbranch_scc0 L_C_end
  s_cmp_ge_u32 s3, 6
  s_cbranch_scc0 L_C_end
  s_cmp_eq_u32 s3, 6
  s_cbranch_scc1 L_F_nog
  s_mov_b32 s20, s98
  s_and_b32 s21, s99, 0xffff
  s_mov_b32 s22, 1152
  s_mov_b32 s23, 0x20000
  s_mov_b32 s24, s100
  s_and_b32 s25, s101, 0xffff
  s_mov_b32 s26, 2304
  s_mov_b32 s27, 0x20000
  v_lshlrev_b32 v12, 1, v2
  buffer_load_ushort v16, v12, s[20:23], 0 offen offset:0
  buffer_load_ushort v32, v12, s[12:15], 0 offen offset:0
  buffer_load_ushort v48, v12, s[12:15], 0 offen offset:1152
  buffer_load_ushort v17, v12, s[20:23], 0 offen offset:128
  buffer_load_ushort v33, v12, s[12:15], 0 offen offset:128
  buffer_load_ushort v49, v12, s[12:15], 0 offen offset:1280
  buffer_load_ushort v18, v12, s[20:23], 0 offen offset:256
  buffer_load_ushort v34, v12, s[12:15], 0 offen offset:256
  buffer_load_ushort v50, v12, s[12:15], 0 offen offset:1408
  buffer_load_ushort v19, v12, s[20:23], 0 offen offset:384
  buffer_load_ushort v35, v12, s[12:15], 0 offen offset:384
  buffer_load_ushort v51, v12, s[12:15], 0 offen offset:1536
  buffer_load_ushort v20, v12, s[20:23], 0 offen offset:512
  buffer_load_ushort v36, v12, s[12:15], 0 offen offset:512
  buffer_load_ushort v52, v12, s[12:15], 0 offen offset:1664
  buffer_load_ushort v21, v12, s[20:23], 0 offen offset:640
  buffer_load_ushort v37, v12, s[12:15], 0 offen offset:640
  buffer_load_ushort v53, v12, s[12:15], 0 offen offset:1792
  buffer_load_ushort v22, v12, s[20:23], 0 offen offset:768
  buffer_load_ushort v38, v12, s[12:15], 0 offen offset:768
  buffer_load_ushort v54, v12, s[12:15], 0 offen offset:1920
  buffer_load_ushort v23, v12, s[20:23], 0 offen offset:896
  buffer_load_ushort v39, v12, s[12:15], 0 offen offset:896
  buffer_load_ushort v55, v12, s[12:15], 0 offen offset:2048
  buffer_load_ushort v24, v12, s[20:23], 0 offen offset:1024
  buffer_load_ushort v40, v12, s[12:15], 0 offen offset:1024
  buffer_load_ushort v56, v12, s[12:15], 0 offen offset:2176
  s_waitcnt vmcnt(0)
  v_mov_b32 v60, 0
  v_mov_b32 v61, 0
  v_lshlrev_b32 v16, 16, v16
  v_lshlrev_b32 v32, 16, v32
  v_lshlrev_b32 v48, 16, v48
  v_mul_f32 v32, v32, v16
  v_mul_f32 v48, v48, v16
  v_cvt_pk_bf16_f32 v62, v32, v48
  v_lshlrev_b32 v63, 16, v62
  v_and_b32 v64, 0xffff0000, v62
  v_add_f32 v60, v60, v63
  v_add_f32 v61, v61, v64
  v_lshlrev_b32 v17, 16, v17
  v_lshlrev_b32 v33, 16, v33
  v_lshlrev_b32 v49, 16, v49
  v_mul_f32 v33, v33, v17
  v_mul_f32 v49, v49, v17
  v_cvt_pk_bf16_f32 v62, v33, v49
  v_lshlrev_b32 v63, 16, v62
  v_and_b32 v64, 0xffff0000, v62
  v_add_f32 v60, v60, v63
  v_add_f32 v61, v61, v64
  v_lshlrev_b32 v18, 16, v18
  v_lshlrev_b32 v34, 16, v34
  v_lshlrev_b32 v50, 16, v50
  v_mul_f32 v34, v34, v18
  v_mul_f32 v50, v50, v18
  v_cvt_pk_bf16_f32 v62, v34, v50
  v_lshlrev_b32 v63, 16, v62
  v_and_b32 v64, 0xffff0000, v62
  v_add_f32 v60, v60, v63
  v_add_f32 v61, v61, v64
  v_lshlrev_b32 v19, 16, v19
  v_lshlrev_b32 v35, 16, v35
  v_lshlrev_b32 v51, 16, v51
  v_mul_f32 v35, v35, v19
  v_mul_f32 v51, v51, v19
  v_cvt_pk_bf16_f32 v62, v35, v51
  v_lshlrev_b32 v63, 16, v62
  v_and_b32 v64, 0xffff0000, v62
  v_add_f32 v60, v60, v63
  v_add_f32 v61, v61, v64
  v_lshlrev_b32 v20, 16, v20
  v_lshlrev_b32 v36, 16, v36
  v_lshlrev_b32 v52, 16, v52
  v_mul_f32 v36, v36, v20
  v_mul_f32 v52, v52, v20
  v_cvt_pk_bf16_f32 v62, v36, v52
  v_lshlrev_b32 v63, 16, v62
  v_and_b32 v64, 0xffff0000, v62
  v_add_f32 v60, v60, v63
  v_add_f32 v61, v61, v64
  v_lshlrev_b32 v21, 16, v21
  v_lshlrev_b32 v37, 16, v37
  v_lshlrev_b32 v53, 16, v53
  v_mul_f32 v37, v37, v21
  v_mul_f32 v53, v53, v21
  v_cvt_pk_bf16_f32 v62, v37, v53
  v_lshlrev_b32 v63, 16, v62
  v_and_b32 v64, 0xffff0000, v62
  v_add_f32 v60, v60, v63
  v_add_f32 v61, v61, v64
  v_lshlrev_b32 v22, 16, v22
  v_lshlrev_b32 v38, 16, v38
  v_lshlrev_b32 v54, 16, v54
  v_mul_f32 v38, v38, v22
  v_mul_f32 v54, v54, v22
  v_cvt_pk_bf16_f32 v62, v38, v54
  v_lshlrev_b32 v63, 16, v62
  v_and_b32 v64, 0xffff0000, v62
  v_add_f32 v60, v60, v63
  v_add_f32 v61, v61, v64
  v_lshlrev_b32 v23, 16, v23
  v_lshlrev_b32 v39, 16, v39
  v_lshlrev_b32 v55, 16, v55
  v_mul_f32 v39, v39, v23
  v_mul_f32 v55, v55, v23
  v_cvt_pk_bf16_f32 v62, v39, v55
  v_lshlrev_b32 v63, 16, v62
  v_and_b32 v64, 0xffff0000, v62
  v_add_f32 v60, v60, v63
  v_add_f32 v61, v61, v64
  v_lshlrev_b32 v24, 16, v24
  v_lshlrev_b32 v40, 16, v40
  v_lshlrev_b32 v56, 16, v56
  v_mul_f32 v40, v40, v24
  v_mul_f32 v56, v56, v24
  v_cvt_pk_bf16_f32 v62, v40, v56
  v_lshlrev_b32 v63, 16, v62
  v_and_b32 v64, 0xffff0000, v62
  v_add_f32 v60, v60, v63
  v_add_f32 v61, v61, v64
  s_nop 1
  v_add_f32_dpp v60, v60, v60 row_ror:8 row_mask:0xf bank_mask:0xf
  v_add_f32_dpp v61, v61, v61 row_ror:8 row_mask:0xf bank_mask:0xf
  s_nop 1
  v_add_f32_dpp v60, v60, v60 row_ror:4 row_mask:0xf bank_mask:0xf
  v_add_f32_dpp v61, v61, v61 row_ror:4 row_mask:0xf bank_mask:0xf
  s_nop 1
  v_add_f32_dpp v60, v60, v60 row_ror:2 row_mask:0xf bank_mask:0xf
  v_add_f32_dpp v61, v61, v61 row_ror:2 row_mask:0xf bank_mask:0xf
  s_nop 1
  v_add_f32_dpp v60, v60, v60 row_ror:1 row_mask:0xf bank_mask:0xf
  v_add_f32_dpp v61, v61, v61 row_ror:1 row_mask:0xf bank_mask:0xf
  s_nop 1
  v_mov_b32 v62, v60
  v_mov_b32 v63, v61
  s_nop 1
  v_permlane16_swap_b32 v60, v62
  v_permlane16_swap_b32 v61, v63
  s_nop 1
  v_add_f32 v60, v60, v62
  v_add_f32 v61, v61, v63
  v_mov_b32 v62, v60
  v_mov_b32 v63, v61
  s_nop 1
  v_permlane32_swap_b32 v60, v62
  v_permlane32_swap_b32 v61, v63
  s_nop 1
  v_add_f32 v60, v60, v62
  v_add_f32 v61, v61, v63
  v_cvt_pk_bf16_f32 v62, v60, v61
  v_lshlrev_b32 v60, 16, v62
  v_and_b32 v61, 0xffff0000, v62
  s_mov_b32 s33, 0xbfb8aa3b
  v_mul_f32 v60, s33, v60
  v_mul_f32 v61, s33, v61
  v_exp_f32 v60, v60
  v_exp_f32 v61, v61
  s_nop 0
  v_add_f32 v60, 1.0, v60
  v_add_f32 v61, 1.0, v61
  v_rcp_f32 v60, v60
  v_rcp_f32 v61, v61
  s_nop 0
  v_cvt_pk_bf16_f32 v62, v60, v61
  v_lshlrev_b32 v60, 16, v62
  v_and_b32 v61, 0xffff0000, v62
  v_cmp_le_u32 vcc, 32, v2
  s_nop 1
  v_cndmask_b32 v60, v60, v61, vcc
L_F_nog:
  s_sub_u32 s58, s3, 6
  s_mul_i32 s59, s58, 144
  s_lshl_b32 s60, s61, 4
  s_add_u32 s59, s59, s60
  s_lshl_b32 s34, s59, 7
  s_add_u32 s34, s34, 12910592
  v_lshlrev_b32 v12, 7, v2
  s_mov_b64 exec, 0xffff
L_poll_32:
  buffer_load_dword v16, v12, s[4:7], s34 offen sc1
  s_waitcnt vmcnt(0)
  v_cmp_ne_u32 vcc, s39, v16
  s_cbranch_vccz L_poll_32_d
  s_add_u32 s62, s62, 1
  s_cmp_gt_u32 s62, 0x1000000
  s_cbranch_scc1 L_bail
  s_sleep 2
  s_branch L_poll_32
L_poll_32_d:
  s_mov_b64 exec, -1
  v_lshlrev_b32 v12, 4, v2
  s_lshl_b32 s34, s59, 10
  s_add_u32 s34, s34, 1900544
  s_add_u32 s35, s34, 4096
  s_add_u32 s36, s34, 8192
  s_add_u32 s37, s34, 12288
L_tl_33:
  buffer_load_dwordx4 v[64:67], v12, s[4:7], s34 offen offset:0 sc1
  buffer_load_dwordx4 v[68:71], v12, s[4:7], s34 offen offset:1024 sc1
  buffer_load_dwordx4 v[72:75], v12, s[4:7], s34 offen offset:2048 sc1
  buffer_load_dwordx4 v[76:79], v12, s[4:7], s34 offen offset:3072 sc1
  buffer_load_dwordx4 v[80:83], v12, s[4:7], s35 offen offset:0 sc1
  buffer_load_dwordx4 v[84:87], v12, s[4:7], s35 offen offset:1024 sc1
  buffer_load_dwordx4 v[88:91], v12, s[4:7], s35 offen offset:2048 sc1
  buffer_load_dwordx4 v[92:95], v12, s[4:7], s35 offen offset:3072 sc1
  buffer_load_dwordx4 v[96:99], v12, s[4:7], s36 offen offset:0 sc1
  buffer_load_dwordx4 v[100:103], v12, s[4:7], s36 offen offset:1024 sc1
  buffer_load_dwordx4 v[104:107], v12, s[4:7], s36 offen offset:2048 sc1
  buffer_load_dwordx4 v[108:111], v12, s[4:7], s36 offen offset:3072 sc1
  buffer_load_dwordx4 v[112:115], v12, s[4:7], s37 offen offset:0 sc1
  buffer_load_dwordx4 v[116:119], v12, s[4:7], s37 offen offset:1024 sc1
  buffer_load_dwordx4 v[120:123], v12, s[4:7], s37 offen offset:2048 sc1
  buffer_load_dwordx4 v[124:127], v12, s[4:7], s37 offen offset:3072 sc1
  s_waitcnt vmcnt(0)
  v_mov_b32 v14, s39
  v_mov_b32 v15, s39
  v_min3_u32 v14, v14, v65, v69
  v_max3_u32 v15, v15, v65, v69
  v_min3_u32 v14, v14, v73, v77
  v_max3_u32 v15, v15, v73, v77
  v_min3_u32 v14, v14, v81, v85
  v_max3_u32 v15, v15, v81, v85
  v_min3_u32 v14, v14, v89, v93
  v_max3_u32 v15, v15, v89, v93
  v_min3_u32 v14, v14, v97, v101
  v_max3_u32 v15, v15, v97, v101
  v_min3_u32 v14, v14, v105, v109
  v_max3_u32 v15, v15, v105, v109
  v_min3_u32 v14, v14, v113, v117
  v_max3_u32 v15, v15, v113, v117
  v_min3_u32 v14, v14, v121, v125
  v_max3_u32 v15, v15, v121, v125
  v_min3_u32 v14, v14, v67, v71
  v_max3_u32 v15, v15, v67, v71
  v_min3_u32 v14, v14, v75, v79
  v_max3_u32 v15, v15, v75, v79
  v_min3_u32 v14, v14, v83, v87
  v_max3_u32 v15, v15, v83, v87
  v_min3_u32 v14, v14, v91, v95
  v_max3_u32 v15, v15, v91, v95
  v_min3_u32 v14, v14, v99, v103
  v_max3_u32 v15, v15, v99, v103
  v_min3_u32 v14, v14, v107, v111
  v_max3_u32 v15, v15, v107, v111
  v_min3_u32 v14, v14, v115, v119
  v_max3_u32 v15, v15, v115, v119
  v_min3_u32 v14, v14, v123, v127
  v_max3_u32 v15, v15, v123, v127
  v_cmp_ne_u32 vcc, v14, v15
  s_cbranch_vccz L_tl_33_d
  s_add_u32 s62, s62, 1
  s_cmp_gt_u32 s62, 0x1000000
  s_cbranch_scc1 L_bail
  s_sleep 2
  s_branch L_tl_33
L_tl_33_d:
  v_mov_b32 v18, v64
  v_mov_b32 v19, v66
  v_add_f32 v18, v18, v68
  v_add_f32 v19, v19, v70
  v_add_f32 v18, v18, v72
  v_add_f32 v19, v19, v74
  v_add_f32 v18, v18, v76
  v_add_f32 v19, v19, v78
  v_add_f32 v18, v18, v80
  v_add_f32 v19, v19, v82
  v_add_f32 v18, v18, v84
  v_add_f32 v19, v19, v86
  v_add_f32 v18, v18, v88
  v_add_f32 v19, v19, v90
  v_add_f32 v18, v18, v92
  v_add_f32 v19, v19, v94
  v_add_f32 v18, v18, v96
  v_add_f32 v19, v19, v98
  v_add_f32 v18, v18, v100
  v_add_f32 v19, v19, v102
  v_add_f32 v18, v18, v104
  v_add_f32 v19, v19, v106
  v_add_f32 v18, v18, v108
  v_add_f32 v19, v19, v110
  v_add_f32 v18, v18, v112
  v_add_f32 v19, v19, v114
  v_add_f32 v18, v18, v116
  v_add_f32 v19, v19, v118
  v_add_f32 v18, v18, v120
  v_add_f32 v19, v19, v122
  v_add_f32 v18, v18, v124
  v_add_f32 v19, v19, v126
  v_lshlrev_b32 v12, 3, v2
  s_cmp_eq_u32 s3, 7
  s_cbranch_scc1 L_F_fin
  ds_write_b64 v12, v[18:19] offset:768
  s_waitcnt lgkmcnt(0)
  v_mov_b32 v12, 148
  v_mov_b32 v13, 1
  ds_write_b32 v12, v13
  s_branch L_C_end
L_F_fin:
  v_mov_b32 v13, 148
L_lw_34:
  ds_read_b32 v14, v13
  s_waitcnt lgkmcnt(0)
  v_readfirstlane_b32 s32, v14
  s_nop 0
  s_cmp_lg_u32 s32, 0
  s_cbranch_scc1 L_lw_34_d
  s_add_u32 s62, s62, 1
  s_cmp_gt_u32 s62, 0x1000000
  s_cbranch_scc1 L_bail
  s_sleep 1
  s_branch L_lw_34
L_lw_34_d:
  ds_read_b64 v[16:17], v12 offset:768
  s_waitcnt lgkmcnt(0)
  v_cvt_pk_bf16_f32 v62, v16, v17
  v_lshlrev_b32 v16, 16, v62
  v_and_b32 v17, 0xffff0000, v62
  v_cvt_pk_bf16_f32 v62, v18, v19
  v_lshlrev_b32 v18, 16, v62
  v_and_b32 v19, 0xffff0000, v62
  v_sub_f32 v61, 1.0, v60
  v_cvt_pk_bf16_f32 v62, v61, v61
  v_lshlrev_b32 v61, 16, v62
  v_mul_f32 v16, v60, v16
  v_mul_f32 v17, v60, v17
  v_cvt_pk_bf16_f32 v62, v16, v17
  v_lshlrev_b32 v16, 16, v62
  v_and_b32 v17, 0xffff0000, v62
  v_mul_f32 v18, v61, v18
  v_mul_f32 v19, v61, v19
  v_cvt_pk_bf16_f32 v62, v18, v19
  v_lshlrev_b32 v18, 16, v62
  v_and_b32 v19, 0xffff0000, v62
  v_add_f32 v16, v16, v18
  v_add_f32 v17, v17, v19
  v_cvt_pk_bf16_f32 v62, v16, v17
  v_lshrrev_b32 v12, 5, v2
  v_mul_u32_u24 v12, 1152, v12
  v_and_b32 v13, 31, v2
  v_lshl_add_u32 v12, v13, 2, v12
  s_lshl_b32 s34, s61, 7
  buffer_store_dword v62, v12, s[24:27], s34 offen
L_C_end:
  s_endpgm
L_A_tail:
  s_load_dwordx2 s[86:87], s[0:1], 32
  s_load_dwordx2 s[96:97], s[0:1], 80
  s_add_u32 s61, s61, 256
  s_waitcnt lgkmcnt(0)
  s_setprio 2
  s_cmp_ge_u32 s61, 144
  s_cselect_b32 s58, 1, 0
  s_mul_i32 s59, s58, 144
  s_sub_u32 s59, s61, s59
  s_and_b32 s60, s59, 15
  s_lshr_b32 s59, s59, 4
  s_cmp_eq_u32 s58, 0
  s_cselect_b32 s54, s86, s96
  s_cselect_b32 s55, s87, s97
  s_mov_b32 s24, s54
  s_and_b32 s25, s55, 0xffff
  s_mov_b32 s26, 4718592
  s_mov_b32 s27, 0x20000
  s_lshl_b32 s33, s60, 8
  s_lshl_b32 s34, s3, 5
  s_add_u32 s33, s33, s34
  v_lshrrev_b32 v12, 3, v2
  v_add_u32 v12, s33, v12
  s_movk_i32 s34, 1152
  v_mul_lo_u32 v12, v12, s34
  v_and_b32 v13, 7, v2
  v_lshl_add_u32 v12, v13, 4, v12
  s_lshl_b32 s34, s59, 7
  buffer_load_dwordx4 v[112:115], v12, s[24:27], s34 offen nt
  s_add_u32 s34, s34, 9216
  buffer_load_dwordx4 v[116:119], v12, s[24:27], s34 offen nt
  s_add_u32 s34, s34, 9216
  buffer_load_dwordx4 v[120:123], v12, s[24:27], s34 offen nt
  s_add_u32 s34, s34, 9216
  buffer_load_dwordx4 v[124:127], v12, s[24:27], s34 offen nt
  s_cmp_ge_u32 s61, 144
  s_cselect_b32 s58, 1, 0
  s_mul_i32 s59, s58, 144
  s_sub_u32 s59, s61, s59
  s_and_b32 s60, s59, 15
  s_lshr_b32 s59, s59, 4
  s_cmp_lg_u32 s3, 0
  s_cbranch_scc1 L_ow_38
  s_cmp_eq_u32 s58, 0
  s_cbranch_scc0 L_op_40
  s_add_u32 s34, s60, 0
  s_lshl_b32 s34, s34, 10
  s_add_u32 s34, s34, 12845056
  v_lshlrev_b32 v12, 7, v2
  s_mov_b64 exec, 0xff
L_poll_41:
  buffer_load_dword v16, v12, s[4:7], s34 offen sc1
  s_waitcnt vmcnt(0)
  v_cmp_ne_u32 vcc, s39, v16
  s_cbranch_vccz L_poll_41_d
  s_add_u32 s62, s62, 1
  s_cmp_gt_u32 s62, 0x1000000
  s_cbranch_scc1 L_bail
  s_sleep 2
  s_branch L_poll_41
L_poll_41_d:
  s_mov_b64 exec, -1
  s_add_u32 s34, s60, 16
  s_lshl_b32 s34, s34, 10
  s_add_u32 s34, s34, 12845056
  v_lshlrev_b32 v12, 7, v2
  s_mov_b64 exec, 0xff
L_poll_42:
  buffer_load_dword v16, v12, s[4:7], s34 offen sc1
  s_waitcnt vmcnt(0)
  v_cmp_ne_u32 vcc, s39, v16
  s_cbranch_vccz L_poll_42_d
  s_add_u32 s62, s62, 1
  s_cmp_gt_u32 s62, 0x1000000
  s_cbranch_scc1 L_bail
  s_sleep 2
  s_branch L_poll_42
L_poll_42_d:
  s_mov_b64 exec, -1
  s_branch L_ow2_39
L_op_40:
  s_lshl_b32 s34, s60, 11
  s_add_u32 s34, s34, 12779520
  v_lshlrev_b32 v12, 7, v2
  s_mov_b64 exec, 0xffff
L_poll_43:
  buffer_load_dword v16, v12, s[4:7], s34 offen sc1
  s_waitcnt vmcnt(0)
  v_cmp_ne_u32 vcc, s39, v16
  s_cbranch_vccz L_poll_43_d
  s_add_u32 s62, s62, 1
  s_cmp_gt_u32 s62, 0x1000000
  s_cbranch_scc1 L_bail
  s_sleep 2
  s_branch L_poll_43
L_poll_43_d:
  s_mov_b64 exec, -1
L_ow2_39:
  s_waitcnt lgkmcnt(0)
  v_mov_b32 v12, 144
  v_mov_b32 v13, 1
  ds_write_b32 v12, v13
L_ow_38:
  v_mov_b32 v12, 144
L_lw_44:
  ds_read_b32 v13, v12
  s_waitcnt lgkmcnt(0)
  v_readfirstlane_b32 s32, v13
  s_nop 0
  s_cmp_lg_u32 s32, 0
  s_cbranch_scc1 L_lw_44_d
  s_add_u32 s62, s62, 1
  s_cmp_gt_u32 s62, 0x1000000
  s_cbranch_scc1 L_bail
  s_sleep 1
  s_branch L_lw_44
L_lw_44_d:
  s_cmp_eq_u32 s58, 0
  s_cbranch_scc0 L_ob_35
  s_lshr_b32 s33, s3, 2
  s_and_b32 s35, s3, 3
  s_lshl_b32 s34, s33, 4
  s_add_u32 s34, s34, s60
  s_lshl_b32 s36, s34, 14
  s_lshl_b32 s37, s35, 9
  s_add_u32 s36, s36, s37
  s_add_u32 s36, s36, 720896
  v_lshlrev_b32 v12, 3, v2
  s_add_u32 s37, s36, 4096
  s_add_u32 s38, s36, 8192
  s_add_u32 s32, s36, 12288
  s_lshl_b32 s34, s34, 8
  s_lshr_b32 s33, s35, 1
  s_lshl_b32 s33, s33, 4
  s_add_u32 s34, s34, s33
  s_add_u32 s34, s34, 1245184
  v_mov_b32 v13, 0
L_tl_45:
  buffer_load_dwordx2 v[16:17], v12, s[4:7], s36 offen offset:0 sc1
  buffer_load_dwordx2 v[18:19], v12, s[4:7], s36 offen offset:2048 sc1
  buffer_load_dwordx2 v[20:21], v12, s[4:7], s37 offen offset:0 sc1
  buffer_load_dwordx2 v[22:23], v12, s[4:7], s37 offen offset:2048 sc1
  buffer_load_dwordx2 v[24:25], v12, s[4:7], s38 offen offset:0 sc1
  buffer_load_dwordx2 v[26:27], v12, s[4:7], s38 offen offset:2048 sc1
  buffer_load_dwordx2 v[28:29], v12, s[4:7], s32 offen offset:0 sc1
  buffer_load_dwordx2 v[30:31], v12, s[4:7], s32 offen offset:2048 sc1
  buffer_load_dwordx4 v[32:35], v13, s[4:7], s34 offen offset:0 sc1
  buffer_load_dwordx4 v[36:39], v13, s[4:7], s34 offen offset:32 sc1
  buffer_load_dwordx4 v[40:43], v13, s[4:7], s34 offen offset:64 sc1
  buffer_load_dwordx4 v[44:47], v13, s[4:7], s34 offen offset:96 sc1
  buffer_load_dwordx4 v[48:51], v13, s[4:7], s34 offen offset:128 sc1
  buffer_load_dwordx4 v[52:55], v13, s[4:7], s34 offen offset:160 sc1
  buffer_load_dwordx4 v[56:59], v13, s[4:7], s34 offen offset:192 sc1
  buffer_load_dwordx4 v[60:63], v13, s[4:7], s34 offen offset:224 sc1
  s_waitcnt vmcnt(0)
  v_mov_b32 v14, s39
  v_mov_b32 v15, s39
  v_min3_u32 v14, v14, v17, v19
  v_max3_u32 v15, v15, v17, v19
  v_min3_u32 v14, v14, v21, v23
  v_max3_u32 v15, v15, v21, v23
  v_min3_u32 v14, v14, v25, v27
  v_max3_u32 v15, v15, v25, v27
  v_min3_u32 v14, v14, v29, v31
  v_max3_u32 v15, v15, v29, v31
  v_min3_u32 v14, v14, v33, v37
  v_max3_u32 v15, v15, v33, v37
  v_min3_u32 v14, v14, v41, v45
  v_max3_u32 v15, v15, v41, v45
  v_min3_u32 v14, v14, v49, v53
  v_max3_u32 v15, v15, v49, v53
  v_min3_u32 v14, v14, v57, v61
  v_max3_u32 v15, v15, v57, v61
  v_min3_u32 v14, v14, v35, v39
  v_max3_u32 v15, v15, v35, v39
  v_min3_u32 v14, v14, v43, v47
  v_max3_u32 v15, v15, v43, v47
  v_min3_u32 v14, v14, v51, v55
  v_max3_u32 v15, v15, v51, v55
  v_min3_u32 v14, v14, v59, v63
  v_max3_u32 v15, v15, v59, v63
  v_cmp_ne_u32 vcc, v14, v15
  s_cbranch_vccz L_tl_45_d
  s_add_u32 s62, s62, 1
  s_cmp_gt_u32 s62, 0x1000000
  s_cbranch_scc1 L_bail
  s_sleep 2
  s_branch L_tl_45
L_tl_45_d:
  v_max_f32 v13, v32, v36
  v_max_f32 v13, v13, v40
  v_max_f32 v13, v13, v44
  v_max_f32 v13, v13, v48
  v_max_f32 v13, v13, v52
  v_max_f32 v13, v13, v56
  v_max_f32 v13, v13, v60
  v_sub_f32 v32, v32, v13
  v_sub_f32 v36, v36, v13
  v_sub_f32 v40, v40, v13
  v_sub_f32 v44, v44, v13
  v_sub_f32 v48, v48, v13
  v_sub_f32 v52, v52, v13
  v_sub_f32 v56, v56, v13
  v_sub_f32 v60, v60, v13
  v_exp_f32 v32, v32
  v_exp_f32 v36, v36
  v_exp_f32 v40, v40
  v_exp_f32 v44, v44
  v_exp_f32 v48, v48
  v_exp_f32 v52, v52
  v_exp_f32 v56, v56
  v_exp_f32 v60, v60
  v_mov_b32 v14, 0
  v_mov_b32 v15, 0
  v_fmac_f32 v14, v32, v34
  v_fmac_f32 v15, v32, v16
  v_fmac_f32 v14, v36, v38
  v_fmac_f32 v15, v36, v18
  v_fmac_f32 v14, v40, v42
  v_fmac_f32 v15, v40, v20
  v_fmac_f32 v14, v44, v46
  v_fmac_f32 v15, v44, v22
  v_fmac_f32 v14, v48, v50
  v_fmac_f32 v15, v48, v24
  v_fmac_f32 v14, v52, v54
  v_fmac_f32 v15, v52, v26
  v_fmac_f32 v14, v56, v58
  v_fmac_f32 v15, v56, v28
  v_fmac_f32 v14, v60, v62
  v_fmac_f32 v15, v60, v30
  v_rcp_f32 v14, v14
  s_nop 0
  v_mul_f32 v15, v15, v14
  s_branch L_oj_36
L_ob_35:
  s_lshr_b32 s33, s3, 2
  s_and_b32 s35, s3, 3
  s_lshr_b32 s37, s35, 1
  s_lshl_b32 s34, s60, 1
  s_add_u32 s34, s34, s37
  s_lshl_b32 s36, s34, 14
  s_lshl_b32 s37, s33, 10
  s_add_u32 s36, s36, s37
  s_and_b32 s37, s35, 1
  s_lshl_b32 s37, s37, 9
  s_add_u32 s36, s36, s37
  s_add_u32 s36, s36, 1376256
  v_lshlrev_b32 v12, 3, v2
  s_add_u32 s37, s36, 4096
  s_add_u32 s38, s36, 8192
  s_add_u32 s32, s36, 12288
L_tl_46:
  buffer_load_dwordx2 v[16:17], v12, s[4:7], s36 offen offset:0 sc1
  buffer_load_dwordx2 v[18:19], v12, s[4:7], s36 offen offset:2048 sc1
  buffer_load_dwordx2 v[20:21], v12, s[4:7], s37 offen offset:0 sc1
  buffer_load_dwordx2 v[22:23], v12, s[4:7], s37 offen offset:2048 sc1
  buffer_load_dwordx2 v[24:25], v12, s[4:7], s38 offen offset:0 sc1
  buffer_load_dwordx2 v[26:27], v12, s[4:7], s38 offen offset:2048 sc1
  buffer_load_dwordx2 v[28:29], v12, s[4:7], s32 offen offset:0 sc1
  buffer_load_dwordx2 v[30:31], v12, s[4:7], s32 offen offset:2048 sc1
  s_waitcnt vmcnt(0)
  v_mov_b32 v14, s39
  v_mov_b32 v15, s39
  v_min3_u32 v14, v14, v17, v19
  v_max3_u32 v15, v15, v17, v19
  v_min3_u32 v14, v14, v21, v23
  v_max3_u32 v15, v15, v21, v23
  v_min3_u32 v14, v14, v25, v27
  v_max3_u32 v15, v15, v25, v27
  v_min3_u32 v14, v14, v29, v31
  v_max3_u32 v15, v15, v29, v31
  v_cmp_ne_u32 vcc, v14, v15
  s_cbranch_vccz L_tl_46_d
  s_add_u32 s62, s62, 1
  s_cmp_gt_u32 s62, 0x1000000
  s_cbranch_scc1 L_bail
  s_sleep 2
  s_branch L_tl_46
L_tl_46_d:
  v_mov_b32 v15, v16
  v_add_f32 v15, v15, v18
  v_add_f32 v15, v15, v20
  v_add_f32 v15, v15, v22
  v_add_f32 v15, v15, v24
  v_add_f32 v15, v15, v26
  v_add_f32 v15, v15, v28
  v_add_f32 v15, v15, v30
L_oj_36:
  v_cvt_pk_bf16_f32 v15, v15, v15
  v_lshlrev_b32 v15, 16, v15
  s_lshl_b32 s34, s3, 8
  s_add_u32 s34, s34, 17408
  v_lshlrev_b32 v12, 2, v2
  v_add_u32 v12, s34, v12
  ds_write_b32 v12, v15
  s_waitcnt lgkmcnt(0)
  v_mov_b32 v12, 84
  v_mov_b32 v13, 1
  s_mov_b64 exec, 1
  ds_add_u32 v12, v13
  s_mov_b64 exec, -1
L_cbar_47:
  ds_read_b32 v13, v12
  s_waitcnt lgkmcnt(0)
  v_readfirstlane_b32 s32, v13
  s_nop 0
  s_cmp_ge_u32 s32, 8
  s_cbranch_scc1 L_cbar_47_d
  s_add_u32 s62, s62, 1
  s_cmp_gt_u32 s62, 0x1000000
  s_cbranch_scc1 L_bail
  s_sleep 0
  s_branch L_cbar_47
L_cbar_47_d:
  s_lshl_b32 s34, s3, 5
  v_lshrrev_b32 v12, 3, v2
  v_add_u32 v12, s34, v12
  v_lshlrev_b32 v12, 2, v12
  v_add_u32 v12, 17408, v12
  ds_read_b32 v16, v12 offset:0
  ds_read_b32 v17, v12 offset:1024
  ds_read_b32 v18, v12 offset:32
  ds_read_b32 v19, v12 offset:1056
  ds_read_b32 v20, v12 offset:64
  ds_read_b32 v21, v12 offset:1088
  ds_read_b32 v22, v12 offset:96
  ds_read_b32 v23, v12 offset:1120
  v_mov_b32 v32, 0
  v_mov_b32 v33, 0
  v_mov_b32 v34, 0
  v_mov_b32 v35, 0
  v_mov_b32 v36, 0
  v_mov_b32 v37, 0
  v_mov_b32 v38, 0
  v_mov_b32 v39, 0
  v_mov_b32 v40, 0
  v_mov_b32 v41, 0
  v_mov_b32 v42, 0
  v_mov_b32 v43, 0
  v_mov_b32 v44, 0
  v_mov_b32 v45, 0
  v_mov_b32 v46, 0
  v_mov_b32 v47, 0
  s_waitcnt vmcnt(0) lgkmcnt(0)
  v_lshlrev_b32 v12, 16, v112
  v_and_b32 v13, 0xffff0000, v112
  v_fmac_f32 v32, v16, v12
  v_fmac_f32 v33, v16, v13
  v_fmac_f32 v40, v17, v12
  v_fmac_f32 v41, v17, v13
  v_lshlrev_b32 v12, 16, v113
  v_and_b32 v13, 0xffff0000, v113
  v_fmac_f32 v34, v16, v12
  v_fmac_f32 v35, v16, v13
  v_fmac_f32 v42, v17, v12
  v_fmac_f32 v43, v17, v13
  v_lshlrev_b32 v12, 16, v114
  v_and_b32 v13, 0xffff0000, v114
  v_fmac_f32 v36, v16, v12
  v_fmac_f32 v37, v16, v13
  v_fmac_f32 v44, v17, v12
  v_fmac_f32 v45, v17, v13
  v_lshlrev_b32 v12, 16, v115
  v_and_b32 v13, 0xffff0000, v115
  v_fmac_f32 v38, v16, v12
  v_fmac_f32 v39, v16, v13
  v_fmac_f32 v46, v17, v12
  v_fmac_f32 v47, v17, v13
  v_lshlrev_b32 v12, 16, v116
  v_and_b32 v13, 0xffff0000, v116
  v_fmac_f32 v32, v18, v12
  v_fmac_f32 v33, v18, v13
  v_fmac_f32 v40, v19, v12
  v_fmac_f32 v41, v19, v13
  v_lshlrev_b32 v12, 16, v117
  v_and_b32 v13, 0xffff0000, v117
  v_fmac_f32 v34, v18, v12
  v_fmac_f32 v35, v18, v13
  v_fmac_f32 v42, v19, v12
  v_fmac_f32 v43, v19, v13
  v_lshlrev_b32 v12, 16, v118
  v_and_b32 v13, 0xffff0000, v118
  v_fmac_f32 v36, v18, v12
  v_fmac_f32 v37, v18, v13
  v_fmac_f32 v44, v19, v12
  v_fmac_f32 v45, v19, v13
  v_lshlrev_b32 v12, 16, v119
  v_and_b32 v13, 0xffff0000, v119
  v_fmac_f32 v38, v18, v12
  v_fmac_f32 v39, v18, v13
  v_fmac_f32 v46, v19, v12
  v_fmac_f32 v47, v19, v13
  v_lshlrev_b32 v12, 16, v120
  v_and_b32 v13, 0xffff0000, v120
  v_fmac_f32 v32, v20, v12
  v_fmac_f32 v33, v20, v13
  v_fmac_f32 v40, v21, v12
  v_fmac_f32 v41, v21, v13
  v_lshlrev_b32 v12, 16, v121
  v_and_b32 v13, 0xffff0000, v121
  v_fmac_f32 v34, v20, v12
  v_fmac_f32 v35, v20, v13
  v_fmac_f32 v42, v21, v12
  v_fmac_f32 v43, v21, v13
  v_lshlrev_b32 v12, 16, v122
  v_and_b32 v13, 0xffff0000, v122
  v_fmac_f32 v36, v20, v12
  v_fmac_f32 v37, v20, v13
  v_fmac_f32 v44, v21, v12
  v_fmac_f32 v45, v21, v13
  v_lshlrev_b32 v12, 16, v123
  v_and_b32 v13, 0xffff0000, v123
  v_fmac_f32 v38, v20, v12
  v_fmac_f32 v39, v20, v13
  v_fmac_f32 v46, v21, v12
  v_fmac_f32 v47, v21, v13
  v_lshlrev_b32 v12, 16, v124
  v_and_b32 v13, 0xffff0000, v124
  v_fmac_f32 v32, v22, v12
  v_fmac_f32 v33, v22, v13
  v_fmac_f32 v40, v23, v12
  v_fmac_f32 v41, v23, v13
  v_lshlrev_b32 v12, 16, v125
  v_and_b32 v13, 0xffff0000, v125
  v_fmac_f32 v34, v22, v12
  v_fmac_f32 v35, v22, v13
  v_fmac_f32 v42, v23, v12
  v_fmac_f32 v43, v23, v13
  v_lshlrev_b32 v12, 16, v126
  v_and_b32 v13, 0xffff0000, v126
  v_fmac_f32 v36, v22, v12
  v_fmac_f32 v37, v22, v13
  v_fmac_f32 v44, v23, v12
  v_fmac_f32 v45, v23, v13
  v_lshlrev_b32 v12, 16, v127
  v_and_b32 v13, 0xffff0000, v127
  v_fmac_f32 v38, v22, v12
  v_fmac_f32 v39, v22, v13
  v_fmac_f32 v46, v23, v12
  v_fmac_f32 v47, v23, v13
  v_add_f32_dpp v32, v32, v32 row_ror:8 row_mask:0xf bank_mask:0xf
  v_add_f32_dpp v33, v33, v33 row_ror:8 row_mask:0xf bank_mask:0xf
  v_add_f32_dpp v34, v34, v34 row_ror:8 row_mask:0xf bank_mask:0xf
  v_add_f32_dpp v35, v35, v35 row_ror:8 row_mask:0xf bank_mask:0xf
  v_add_f32_dpp v36, v36, v36 row_ror:8 row_mask:0xf bank_mask:0xf
  v_add_f32_dpp v37, v37, v37 row_ror:8 row_mask:0xf bank_mask:0xf
  v_add_f32_dpp v38, v38, v38 row_ror:8 row_mask:0xf bank_mask:0xf
  v_add_f32_dpp v39, v39, v39 row_ror:8 row_mask:0xf bank_mask:0xf
  v_add_f32_dpp v40, v40, v40 row_ror:8 row_mask:0xf bank_mask:0xf
  v_add_f32_dpp v41, v41, v41 row_ror:8 row_mask:0xf bank_mask:0xf
  v_add_f32_dpp v42, v42, v42 row_ror:8 row_mask:0xf bank_mask:0xf
  v_add_f32_dpp v43, v43, v43 row_ror:8 row_mask:0xf bank_mask:0xf
  v_add_f32_dpp v44, v44, v44 row_ror:8 row_mask:0xf bank_mask:0xf
  v_add_f32_dpp v45, v45, v45 row_ror:8 row_mask:0xf bank_mask:0xf
  v_add_f32_dpp v46, v46, v46 row_ror:8 row_mask:0xf bank_mask:0xf
  v_add_f32_dpp v47, v47, v47 row_ror:8 row_mask:0xf bank_mask:0xf
  v_mov_b32 v48, v32
  v_mov_b32 v49, v33
  v_mov_b32 v50, v34
  v_mov_b32 v51, v35
  v_mov_b32 v52, v36
  v_mov_b32 v53, v37
  v_mov_b32 v54, v38
  v_mov_b32 v55, v39
  v_mov_b32 v56, v40
  v_mov_b32 v57, v41
  v_mov_b32 v58, v42
  v_mov_b32 v59, v43
  v_mov_b32 v60, v44
  v_mov_b32 v61, v45
  v_mov_b32 v62, v46
  v_mov_b32 v63, v47
  v_permlane16_swap_b32 v32, v48
  v_permlane16_swap_b32 v33, v49
  v_permlane16_swap_b32 v34, v50
  v_permlane16_swap_b32 v35, v51
  v_permlane16_swap_b32 v36, v52
  v_permlane16_swap_b32 v37, v53
  v_permlane16_swap_b32 v38, v54
  v_permlane16_swap_b32 v39, v55
  v_permlane16_swap_b32 v40, v56
  v_permlane16_swap_b32 v41, v57
  v_permlane16_swap_b32 v42, v58
  v_permlane16_swap_b32 v43, v59
  v_permlane16_swap_b32 v44, v60
  v_permlane16_swap_b32 v45, v61
  v_permlane16_swap_b32 v46, v62
  v_permlane16_swap_b32 v47, v63
  v_add_f32 v32, v32, v48
  v_add_f32 v33, v33, v49
  v_add_f32 v34, v34, v50
  v_add_f32 v35, v35, v51
  v_add_f32 v36, v36, v52
  v_add_f32 v37, v37, v53
  v_add_f32 v38, v38, v54
  v_add_f32 v39, v39, v55
  v_add_f32 v40, v40, v56
  v_add_f32 v41, v41, v57
  v_add_f32 v42, v42, v58
  v_add_f32 v43, v43, v59
  v_add_f32 v44, v44, v60
  v_add_f32 v45, v45, v61
  v_add_f32 v46, v46, v62
  v_add_f32 v47, v47, v63
  v_mov_b32 v48, v32
  v_mov_b32 v49, v33
  v_mov_b32 v50, v34
  v_mov_b32 v51, v35
  v_mov_b32 v52, v36
  v_mov_b32 v53, v37
  v_mov_b32 v54, v38
  v_mov_b32 v55, v39
  v_mov_b32 v56, v40
  v_mov_b32 v57, v41
  v_mov_b32 v58, v42
  v_mov_b32 v59, v43
  v_mov_b32 v60, v44
  v_mov_b32 v61, v45
  v_mov_b32 v62, v46
  v_mov_b32 v63, v47
  v_permlane32_swap_b32 v32, v48
  v_permlane32_swap_b32 v33, v49
  v_permlane32_swap_b32 v34, v50
  v_permlane32_swap_b32 v35, v51
  v_permlane32_swap_b32 v36, v52
  v_permlane32_swap_b32 v37, v53
  v_permlane32_swap_b32 v38, v54
  v_permlane32_swap_b32 v39, v55
  v_permlane32_swap_b32 v40, v56
  v_permlane32_swap_b32 v41, v57
  v_permlane32_swap_b32 v42, v58
  v_permlane32_swap_b32 v43, v59
  v_permlane32_swap_b32 v44, v60
  v_permlane32_swap_b32 v45, v61
  v_permlane32_swap_b32 v46, v62
  v_permlane32_swap_b32 v47, v63
  v_add_f32 v32, v32, v48
  v_add_f32 v33, v33, v49
  v_add_f32 v34, v34, v50
  v_add_f32 v35, v35, v51
  v_add_f32 v36, v36, v52
  v_add_f32 v37, v37, v53
  v_add_f32 v38, v38, v54
  v_add_f32 v39, v39, v55
  v_add_f32 v40, v40, v56
  v_add_f32 v41, v41, v57
  v_add_f32 v42, v42, v58
  v_add_f32 v43, v43, v59
  v_add_f32 v44, v44, v60
  v_add_f32 v45, v45, v61
  v_add_f32 v46, v46, v62
  v_add_f32 v47, v47, v63
  s_lshl_b32 s34, s3, 9
  s_add_u32 s34, s34, 105984
  v_lshlrev_b32 v12, 5, v2
  v_add_u32 v12, s34, v12
  s_mov_b64 exec, 0xff
  ds_write_b128 v12, v[32:35]
  ds_write_b128 v12, v[36:39] offset:16
  ds_write_b128 v12, v[40:43] offset:256
  ds_write_b128 v12, v[44:47] offset:272
  s_mov_b64 exec, -1
  s_waitcnt lgkmcnt(0)
  v_mov_b32 v12, 24
  v_mov_b32 v13, 1
  s_mov_b64 exec, 1
  ds_add_rtn_u32 v13, v12, v13
  s_waitcnt lgkmcnt(0)
  s_mov_b64 exec, -1
  v_readfirstlane_b32 s32, v13
  s_nop 0
  s_cmp_lg_u32 s32, 7
  s_cbranch_scc1 L_od_37
  v_lshlrev_b32 v12, 3, v2
  v_add_u32 v13, 105984, v12
  ds_read_b64 v[16:17], v13 offset:0
  ds_read_b64 v[18:19], v13 offset:512
  ds_read_b64 v[20:21], v13 offset:1024
  ds_read_b64 v[22:23], v13 offset:1536
  ds_read_b64 v[24:25], v13 offset:2048
  ds_read_b64 v[26:27], v13 offset:2560
  ds_read_b64 v[28:29], v13 offset:3072
  ds_read_b64 v[30:31], v13 offset:3584
  s_waitcnt lgkmcnt(0)
  v_add_f32 v16, v16, v18
  v_add_f32 v17, v17, v19
  v_add_f32 v16, v16, v20
  v_add_f32 v17, v17, v21
  v_add_f32 v16, v16, v22
  v_add_f32 v17, v17, v23
  v_add_f32 v16, v16, v24
  v_add_f32 v17, v17, v25
  v_add_f32 v16, v16, v26
  v_add_f32 v17, v17, v27
  v_add_f32 v16, v16, v28
  v_add_f32 v17, v17, v29
  v_add_f32 v16, v16, v30
  v_add_f32 v17, v17, v31
  v_mov_b32 v18, v17
  v_mov_b32 v17, s39
  v_mov_b32 v19, s39
  s_lshl_b32 s34, s61, 10
  s_add_u32 s34, s34, 1900544
  v_lshlrev_b32 v12, 4, v2
  buffer_store_dwordx4 v[16:19], v12, s[4:7], s34 offen sc1
  s_lshl_b32 s33, s61, 7
  s_add_u32 s33, s33, 12910592
  v_mov_b32 v12, 0
  v_mov_b32 v13, s39
  s_mov_b64 exec, 1
  buffer_store_dword v13, v12, s[4:7], s33 offen sc1
  s_mov_b64 exec, -1
L_od_37:
  s_endpgm
L_bail:
  s_endpgm
L_exit:
  s_endpgm
.section .rodata,"a"
.p2align 6
.amdhsa_kernel gated_mix__gqa_block_cached__compressed_kv_cla__decode_kernel
  .amdhsa_next_free_vgpr 128
  .amdhsa_next_free_sgpr 102
  .amdhsa_accum_offset 128
  .amdhsa_group_segment_fixed_size 0
  .amdhsa_kernarg_size 120
  .amdhsa_user_sgpr_count 2
  .amdhsa_user_sgpr_kernarg_segment_ptr 1
  .amdhsa_system_sgpr_workgroup_id_x 1
.end_amdhsa_kernel
```
